```python
import torch

def _softmax(x, axis=-1):
    return torch.softmax(x, dim=axis)
def _gelu(x):
    return torch.nn.functional.gelu(x, approximate="tanh")
def _silu(x):
    return torch.nn.functional.silu(x)
def _sigmoid(x):
    return torch.sigmoid(x)
def _layernorm(x, axis=-1, eps=1e-5):
    m = x.mean(dim=axis, keepdim=True)
    v = x.var(dim=axis, keepdim=True, unbiased=False)
    return (x - m) / torch.sqrt(v + eps)
def _scatter_add(tgt, idx, src, axis=0):
    return tgt.clone().index_add_(axis, idx, src)
def _segment_sum(src, seg, n):
    out = torch.zeros((n,) + src.shape[1:], dtype=src.dtype)
    return out.index_add_(0, seg, src)
def _pad(x, pw):
    flat = tuple(v for pair in reversed(pw) for v in pair)
    return torch.nn.functional.pad(x, flat)

kernel_name = 'recurrent_scan__ssm_conv_h3__dense_activation_mish__prompt'

def setup_inputs():

    _w = (lambda a: (lambda t: t.to(torch.bfloat16) if t.is_floating_point() else t)(torch.as_tensor(a)))
    def _A_setup():
        B, S, D = 1, 2048, 512
        ks = 4
        return {
            "q": _w((lambda *s: torch.randn(*s, dtype=torch.bfloat16) * 0.05)(B, S, D)),
            "k": _w((lambda *s: torch.randn(*s, dtype=torch.bfloat16) * 0.8)(B, S, D)),
            "v": _w((lambda *s: torch.randn(*s, dtype=torch.bfloat16) * 0.8)(B, S, D)),
            "shift_k": _w((lambda *s: torch.randn(*s, dtype=torch.bfloat16) * 0.8)(D, ks) * 0.5),
            "ssm_k": _w((lambda *s: torch.randn(*s, dtype=torch.bfloat16) * 0.8)(D, S) * (1.0 / S ** 0.5)),
            "ssm_D": _w((lambda *s: torch.randn(*s, dtype=torch.bfloat16) * 0.8)(D)),
        }
    _A_in = _A_setup()

    def _B_setup():
        B, S, D, F = 1, 2048, 512, 1792
        return {
            "x": _w((lambda *s: torch.randn(*s, dtype=torch.bfloat16) * 0.05)(B, S, D)),
            "w1": _w((lambda *s: torch.randn(*s, dtype=torch.bfloat16) * 0.8)(D, F) * (D ** -0.5)),
            "b1": _w((lambda *s: torch.randn(*s, dtype=torch.bfloat16) * 0.2)(F)),
            "w2": _w((lambda *s: torch.randn(*s, dtype=torch.bfloat16) * 0.2)(F, D) * (F ** -0.5)),
        }
    _B_in = _B_setup()

    return {
        "A_q": _A_in["q"],
        "A_k": _A_in["k"],
        "A_v": _A_in["v"],
        "A_shift_k": _A_in["shift_k"],
        "A_ssm_k": _A_in["ssm_k"],
        "A_ssm_D": _A_in["ssm_D"],
        "B_x": _B_in["x"],
        "B_w1": _B_in["w1"],
        "B_b1": _B_in["b1"],
        "B_w2": _B_in["w2"],
    }

def reference(A_q, A_k, A_v, A_shift_k, A_ssm_k, A_ssm_D, B_x, B_w1, B_b1, B_w2):
    def _A_ref(q, k, v, shift_k, ssm_k, ssm_D):
        B, S, D = q.shape
        ks = shift_k.shape[-1]
        k_pad = _pad(k, ((0, 0), (ks - 1, 0), (0, 0)))
        k_shift = torch.zeros_like(k)
        for t in range(ks):
            k_shift = k_shift + k_pad[:, t:t + S, :] * shift_k[:, ks - 1 - t][None, None, :]
        kv = k_shift * v
        L = 2 * S
        kv_pad = _pad(kv, ((0, 0), (0, S), (0, 0)))
        kf_pad = _pad(ssm_k, ((0, 0), (0, S)))
        kv_f = (lambda x, axes=(-2,-1): torch.fft.rfft2(x.float(), dim=axes))(kv_pad[:, None, :, :], axes=(1, 2))
        kf_f = (lambda x, axes=(-2,-1): torch.fft.rfft2(x.float(), dim=axes))(kf_pad[:, None, :], axes=(1, 2))
        kf_f = (lambda x, *d: x.permute(*d))(kf_f, 1, 2, 0)
        y_f = kv_f * kf_f[None, :, :, :]
        y = (lambda x, s, axes=(-2,-1): torch.fft.irfft2(x, s=s, dim=axes).to(torch.bfloat16))(y_f, (1, L), axes=(1, 2))[:, 0, :S, :]
        y = y + kv * ssm_D[None, None, :]
        return q * y

    def _B_ref(x, w1, b1, w2):
        h = torch.einsum("bsd,df->bsf", x, w1) + b1
        sp = torch.log1p(torch.exp(-torch.abs(h))) + torch.where(h > 0, h, torch.zeros_like(h))
        act = h * torch.tanh(sp)
        return torch.einsum("bsf,fd->bsd", act, w2)

    x = A_q
    xn = _layernorm(x, axis=-1)
    s = _A_ref(xn, A_k, A_v, A_shift_k, A_ssm_k, A_ssm_D)
    g = _silu(_B_ref(xn, B_w1, B_b1, B_w2))
    return x + s * g
```

```asm
; @launch grid=(256,1,1) block=(256,1,1) lds=163840
.amdgcn_target "amdgcn-amd-amdhsa--gfx950"
.text
.globl recurrent_scan__ssm_conv_h3__dense_activation_mish__prompt_kernel
.p2align 8
.type recurrent_scan__ssm_conv_h3__dense_activation_mish__prompt_kernel,@function
recurrent_scan__ssm_conv_h3__dense_activation_mish__prompt_kernel:
    s_cmp_ge_u32 s2, 256
    s_cbranch_scc0 L_start
    s_endpgm
L_start:
    s_load_dwordx16 s[4:19], s[0:1], 0
    s_load_dwordx8 s[20:27], s[0:1], 64
    s_load_dwordx2 s[28:29], s[0:1], 96
    v_and_b32 v1, 63, v0
    v_lshrrev_b32 v2, 6, v0
    v_mov_b32 v250, 0
    v_mov_b32 v251, 0
    s_and_b32 s88, s2, 7
    s_lshr_b32 s76, s2, 3
    v_readfirstlane_b32 s3, v2
    s_and_b32 s80, s76, 3
    s_lshl_b32 s72, s88, 2
    s_add_u32 s72, s72, s80
    s_lshr_b32 s73, s76, 2
    s_mul_i32 s80, s76, 37
    s_lshr_b32 s80, s80, 8
    s_mul_i32 s81, s80, 7
    s_sub_u32 s81, s76, s81
    s_lshr_b32 s74, s88, 1
    s_lshl_b32 s74, s74, 2
    s_add_u32 s74, s74, s80
    s_and_b32 s75, s88, 1
    s_mul_i32 s75, s75, 7
    s_add_u32 s75, s75, s81
    s_lshl_b32 s94, s80, 1
    s_add_u32 s94, s94, s81
    s_lshl_b32 s77, s3, 12
    s_lshr_b32 s86, s3, 1
    s_and_b32 s87, s3, 1
    s_lshl_b32 s89, s2, 1
    s_add_u32 s89, s89, s86
    v_lshrrev_b32 v2, 3, v1
    v_and_b32 v3, 7, v1
    v_lshlrev_b32 v2, 10, v2
    v_lshl_or_b32 v2, v3, 4, v2
    s_lshl_b32 s82, s72, 16
    s_lshl_b32 s83, s73, 7
    s_add_u32 s82, s82, s83
    v_add_u32 v4, s82, v2
    v_subrev_u32 v5, 8192, v4
    s_waitcnt lgkmcnt(0)
    s_mov_b32 s36, s6
    s_mov_b32 s37, s7
    s_mov_b32 s38, 2097152
    s_mov_b32 s39, 0x00020000
    s_mov_b32 s40, s8
    s_mov_b32 s41, s9
    s_mov_b32 s42, 2097152
    s_mov_b32 s43, 0x00020000
    s_mov_b32 s32, s4
    s_mov_b32 s33, s5
    s_mov_b32 s34, 2097152
    s_mov_b32 s35, 0x00020000
    s_cmp_lg_u32 s3, 0
    s_cbranch_scc1 L_w0_1
    s_mov_b32 m0, 98304
    s_nop 0
    buffer_load_dwordx4 v5, s[36:39], 0 offen lds
L_w0_1:
    s_lshl_b32 s82, s3, 14
    s_lshl_b32 s83, s3, 11
    s_add_u32 s84, s82, 8192
    s_add_u32 m0, s83, 99328
    s_nop 0
    buffer_load_dwordx4 v4, s[36:39], s82 offen lds
    s_add_u32 m0, s83, 100352
    s_nop 0
    buffer_load_dwordx4 v4, s[36:39], s84 offen lds
    s_add_u32 m0, s83, 107520
    s_nop 0
    buffer_load_dwordx4 v4, s[40:43], s82 offen lds
    s_add_u32 m0, s83, 108544
    s_nop 0
    buffer_load_dwordx4 v4, s[40:43], s84 offen lds
    v_and_b32 v6, 31, v1
    s_lshl_b32 s80, s73, 9
    v_lshl_add_u32 v7, v6, 4, s80
    global_load_dwordx4 v[28:31], v7, s[10:11]
    s_lshl_b32 s80, s2, 13
    s_lshl_b32 s81, s3, 11
    s_add_u32 s80, s80, s81
    v_lshlrev_b32 v8, 4, v1
    buffer_load_dwordx4 v[224:227], v8, s[32:35], s80 offen
    buffer_load_dwordx4 v[228:231], v8, s[32:35], s80 offen offset:1024
    s_mov_b32 s48, s18
    s_mov_b32 s49, s19
    s_mov_b32 s50, 1835008
    s_mov_b32 s51, 0x00020000
    s_mov_b32 s56, s28
    s_mov_b32 s57, s29
    s_mov_b32 s58, 14680064
    s_mov_b32 s59, 0x00020000
    s_mov_b32 s64, s26
    s_mov_b32 s65, s27
    s_mov_b32 s66, 256
    s_mov_b32 s67, 0x00020000
    s_mov_b32 s52, s22
    s_mov_b32 s53, s23
    s_mov_b32 s54, 1835008
    s_mov_b32 s55, 0x00020000
    s_mov_b32 s60, s24
    s_mov_b32 s61, s25
    s_mov_b32 s62, 2097152
    s_mov_b32 s63, 0x00020000
    s_lshl_b32 s80, s89, 12
    s_add_u32 s44, s12, s80
    s_addc_u32 s45, s13, 0
    s_mov_b32 s46, 4096
    s_mov_b32 s47, 0x00020000
    s_load_dwordx2 s[4:5], s[44:45], 0
    s_or_b32 s80, s2, s3
    s_cmp_lg_u32 s80, 0
    s_cbranch_scc1 L_nononce_2
    s_memrealtime s[90:91]
    s_waitcnt lgkmcnt(0)
    s_or_b32 s90, s90, 1
    v_mov_b32 v244, s90
    v_mov_b32 v245, s91
    v_mov_b32 v246, 0
    s_mov_b64 s[92:93], exec
    s_mov_b64 exec, 1
    buffer_store_dwordx2 v[244:245], v246, s[64:67], 0 offen sc1
    s_mov_b64 exec, s[92:93]
L_nononce_2:
    s_cmp_ge_u32 s76, 28
    s_cbranch_scc1 L_helper
    v_lshrrev_b32 v12, 3, v1
    v_and_b32 v13, 7, v1
    v_lshrrev_b32 v14, 4, v1
    v_xor_b32 v15, v13, v14
    v_lshlrev_b32 v12, 10, v12
    v_lshl_or_b32 v180, v15, 4, v12
    v_xor_b32 v181, 64, v180
    v_and_b32 v13, 15, v1
    v_lshrrev_b32 v15, 2, v13
    v_xor_b32 v15, v15, v14
    v_and_b32 v13, 3, v13
    v_lshlrev_b32 v13, 4, v13
    v_lshl_or_b32 v13, v15, 6, v13
    v_mul_u32_u24 v12, 3584, v14
    v_add_u32 v182, v12, v13
    s_lshl_b32 s78, s74, 17
    s_lshl_b32 s80, s3, 15
    s_add_u32 s78, s78, s80
    s_mul_i32 s79, s3, 57344
    s_lshl_b32 s80, s75, 8
    s_add_u32 s79, s79, s80
    s_add_u32 s85, s94, 0
    s_and_b32 s85, s85, 7
    s_lshl_b32 s30, s85, 7
    s_add_u32 s30, s30, s78
    s_mul_i32 s31, s85, 229376
    s_add_u32 s31, s31, s79
    s_add_u32 m0, s77, 0
    s_nop 0
    buffer_load_dwordx4 v180, s[32:35], s30 offen lds
    s_add_u32 s85, s30, 8192
    s_add_u32 m0, s77, 1024
    s_nop 0
    buffer_load_dwordx4 v181, s[32:35], s85 offen lds
    s_add_u32 s85, s30, 16384
    s_add_u32 m0, s77, 2048
    s_nop 0
    buffer_load_dwordx4 v180, s[32:35], s85 offen lds
    s_add_u32 s85, s30, 24576
    s_add_u32 m0, s77, 3072
    s_nop 0
    buffer_load_dwordx4 v181, s[32:35], s85 offen lds
    s_add_u32 m0, s77, 16384
    s_nop 0
    buffer_load_dwordx4 v182, s[48:51], s31 offen lds
    s_add_u32 s85, s31, 14336
    s_add_u32 m0, s77, 17408
    s_nop 0
    buffer_load_dwordx4 v182, s[48:51], s85 offen lds
    s_add_u32 s85, s31, 28672
    s_add_u32 m0, s77, 18432
    s_nop 0
    buffer_load_dwordx4 v182, s[48:51], s85 offen lds
    s_add_u32 s85, s31, 43008
    s_add_u32 m0, s77, 19456
    s_nop 0
    buffer_load_dwordx4 v182, s[48:51], s85 offen lds
    s_getpc_b64 s[82:83]
L_pcbase:
    s_lshl_b32 s80, s76, 1
    s_add_u32 s80, s80, s3
    s_lshl_b32 s80, s80, 10
    s_cmp_ge_u32 s3, 2
    s_cbranch_scc1 L_nopf_3
    s_add_u32 s81, s80, 1024
    s_cmp_gt_u32 s81, L_codeend-L_pcbase
    s_cbranch_scc1 L_nopf_3
    v_lshl_add_u32 v239, v1, 4, s80
    global_load_dwordx4 v[240:243], v239, s[82:83]
L_nopf_3:
    v_and_b32 v12, 31, v1
    v_lshrrev_b32 v13, 5, v1
    v_bfe_u32 v14, v1, 1, 3
    v_xor_b32 v14, v14, v13
    v_lshlrev_b32 v14, 4, v14
    v_lshl_or_b32 v14, v12, 7, v14
    s_lshl_b32 s80, s87, 13
    v_add_u32 v168, s80, v14
    v_xor_b32 v169, 32, v168
    v_xor_b32 v170, 64, v168
    v_xor_b32 v171, 96, v168
    v_add_u32 v172, 0x10000, v168
    v_add_u32 v173, 0x10000, v169
    v_add_u32 v174, 0x10000, v170
    v_add_u32 v175, 0x10000, v171
    v_bfe_u32 v12, v1, 2, 2
    v_lshl_add_u32 v13, v13, 3, v12
    v_lshlrev_b32 v13, 8, v13
    v_xor_b32 v14, s3, v12
    v_lshl_or_b32 v13, v14, 6, v13
    v_bfe_u32 v14, v1, 4, 1
    v_lshl_or_b32 v13, v14, 5, v13
    v_and_b32 v14, 3, v1
    v_lshl_or_b32 v13, v14, 3, v13
    v_add_u32 v176, 16384, v13
    v_xor_b32 v177, 64, v176
    v_add_u32 v178, 0x10000, v176
    v_add_u32 v179, 0x10000, v177
    v_and_b32 v12, 7, v1
    v_bfe_u32 v13, v1, 4, 1
    v_lshlrev_b32 v13, 2, v13
    v_cmp_eq_u32 vcc, v12, v13
    v_mov_b32 v14, 0x3f803f80
    s_nop 0
    v_cndmask_b32 v164, 0, v14, vcc
    v_mov_b32 v165, v164
    v_mov_b32 v166, v164
    v_mov_b32 v167, v164
    v_and_b32 v12, 31, v1
    v_lshrrev_b32 v13, 5, v1
    s_lshl_b32 s80, s3, 1
    v_add_u32 v14, s80, v13
    v_lshlrev_b32 v15, 10, v14
    v_lshl_or_b32 v15, v12, 2, v15
    v_add_u32 v16, 98944, v15
    v_add_u32 v17, 107520, v15
    v_lshrrev_b32 v15, 2, v12
    v_lshlrev_b32 v18, 2, v13
    v_xor_b32 v15, v15, v18
    v_lshlrev_b32 v15, 4, v15
    v_and_b32 v18, 3, v12
    v_lshl_or_b32 v15, v18, 2, v15
    v_lshl_or_b32 v15, v14, 10, v15
    v_add_u32 v104, 131072, v15
    v_xor_b32 v105, 16, v104
    v_xor_b32 v106, 32, v104
    v_xor_b32 v107, 48, v104
    v_lshrrev_b32 v12, 4, v1
    v_bfe_u32 v13, v1, 2, 2
    v_lshl_add_u32 v14, v12, 3, v13
    v_sub_u32 v14, 31, v14
    v_bfe_u32 v15, v1, 1, 1
    s_lshl_b32 s80, s3, 1
    v_add_u32 v15, s80, v15
    v_and_b32 v18, 1, v1
    v_bfe_u32 v19, v14, 1, 3
    v_xor_b32 v19, v19, v15
    v_lshlrev_b32 v19, 4, v19
    v_lshl_or_b32 v19, v18, 3, v19
    v_lshl_or_b32 v19, v14, 7, v19
    v_add_u32 v108, 131072, v19
    v_subrev_u32 v14, 4, v14
    v_bfe_u32 v19, v14, 1, 3
    v_xor_b32 v19, v19, v15
    v_lshlrev_b32 v19, 4, v19
    v_lshl_or_b32 v19, v18, 3, v19
    v_lshl_or_b32 v19, v14, 7, v19
    v_add_u32 v109, 131072, v19
    v_and_b32 v110, 15, v1
    v_lshlrev_b32 v110, 12, v110
    v_lshl_or_b32 v110, v12, 4, v110
    s_waitcnt lgkmcnt(0)
    s_waitcnt vmcnt(11)
    s_barrier
    ds_read_b32 v188, v16 offset:0
    ds_read_b32 v189, v16 offset:128
    ds_read_b32 v190, v16 offset:256
    ds_read_b32 v191, v16 offset:384
    ds_read_b32 v192, v16 offset:512
    ds_read_b32 v193, v16 offset:640
    ds_read_b32 v194, v16 offset:768
    ds_read_b32 v195, v16 offset:896
    ds_read_b32 v196, v16 offset:1024
    ds_read_b32 v197, v16 offset:1152
    ds_read_b32 v198, v16 offset:1280
    ds_read_b32 v20, v17 offset:0
    ds_read_b32 v21, v17 offset:128
    ds_read_b32 v22, v17 offset:256
    ds_read_b32 v23, v17 offset:384
    s_waitcnt vmcnt(10)
    v_lshlrev_b32 v54, 16, v28
    v_lshlrev_b32 v55, 16, v30
    v_and_b32 v56, 0xffff0000, v28
    v_and_b32 v57, 0xffff0000, v30
    v_lshlrev_b32 v58, 16, v29
    v_lshlrev_b32 v59, 16, v31
    v_and_b32 v60, 0xffff0000, v29
    v_and_b32 v61, 0xffff0000, v31
    s_waitcnt lgkmcnt(14)
    v_lshlrev_b32 v32, 16, v188
    v_and_b32 v33, 0xffff0000, v188
    s_waitcnt lgkmcnt(13)
    v_lshlrev_b32 v34, 16, v189
    v_and_b32 v35, 0xffff0000, v189
    s_waitcnt lgkmcnt(12)
    v_lshlrev_b32 v36, 16, v190
    v_and_b32 v37, 0xffff0000, v190
    s_waitcnt lgkmcnt(11)
    v_lshlrev_b32 v38, 16, v191
    v_and_b32 v39, 0xffff0000, v191
    ds_read_b32 v24, v17 offset:512
    ds_read_b32 v25, v17 offset:640
    ds_read_b32 v26, v17 offset:768
    ds_read_b32 v27, v17 offset:896
    s_waitcnt lgkmcnt(14)
    v_lshlrev_b32 v40, 16, v192
    v_and_b32 v41, 0xffff0000, v192
    s_waitcnt lgkmcnt(13)
    v_lshlrev_b32 v42, 16, v193
    v_and_b32 v43, 0xffff0000, v193
    s_waitcnt lgkmcnt(12)
    v_lshlrev_b32 v44, 16, v194
    v_and_b32 v45, 0xffff0000, v194
    s_waitcnt lgkmcnt(11)
    v_lshlrev_b32 v46, 16, v195
    v_and_b32 v47, 0xffff0000, v195
    s_waitcnt lgkmcnt(10)
    v_lshlrev_b32 v48, 16, v196
    v_and_b32 v49, 0xffff0000, v196
    s_waitcnt lgkmcnt(9)
    v_lshlrev_b32 v50, 16, v197
    v_and_b32 v51, 0xffff0000, v197
    s_waitcnt lgkmcnt(8)
    v_lshlrev_b32 v52, 16, v198
    v_and_b32 v53, 0xffff0000, v198
    s_add_u32 s85, s94, 1
    s_and_b32 s85, s85, 7
    s_lshl_b32 s30, s85, 7
    s_add_u32 s30, s30, s78
    s_mul_i32 s31, s85, 229376
    s_add_u32 s31, s31, s79
    s_add_u32 m0, s77, 32768
    s_nop 0
    buffer_load_dwordx4 v180, s[32:35], s30 offen lds
    s_add_u32 s85, s30, 8192
    s_add_u32 m0, s77, 33792
    s_nop 0
    buffer_load_dwordx4 v181, s[32:35], s85 offen lds
    v_pk_mul_f32 v[64:65], v[38:39], v[54:55]
    v_pk_mul_f32 v[66:67], v[40:41], v[54:55]
    v_pk_mul_f32 v[68:69], v[42:43], v[54:55]
    v_pk_mul_f32 v[70:71], v[44:45], v[54:55]
    v_pk_mul_f32 v[72:73], v[46:47], v[54:55]
    v_pk_mul_f32 v[74:75], v[48:49], v[54:55]
    v_pk_mul_f32 v[76:77], v[50:51], v[54:55]
    v_pk_mul_f32 v[78:79], v[52:53], v[54:55]
    s_add_u32 s85, s30, 16384
    s_add_u32 m0, s77, 34816
    s_nop 0
    buffer_load_dwordx4 v180, s[32:35], s85 offen lds
    s_add_u32 s85, s30, 24576
    s_add_u32 m0, s77, 35840
    s_nop 0
    buffer_load_dwordx4 v181, s[32:35], s85 offen lds
    v_pk_fma_f32 v[64:65], v[36:37], v[56:57], v[64:65]
    v_pk_fma_f32 v[66:67], v[38:39], v[56:57], v[66:67]
    v_pk_fma_f32 v[68:69], v[40:41], v[56:57], v[68:69]
    v_pk_fma_f32 v[70:71], v[42:43], v[56:57], v[70:71]
    v_pk_fma_f32 v[72:73], v[44:45], v[56:57], v[72:73]
    v_pk_fma_f32 v[74:75], v[46:47], v[56:57], v[74:75]
    v_pk_fma_f32 v[76:77], v[48:49], v[56:57], v[76:77]
    v_pk_fma_f32 v[78:79], v[50:51], v[56:57], v[78:79]
    s_add_u32 m0, s77, 49152
    s_nop 0
    buffer_load_dwordx4 v182, s[48:51], s31 offen lds
    s_add_u32 s85, s31, 14336
    s_add_u32 m0, s77, 50176
    s_nop 0
    buffer_load_dwordx4 v182, s[48:51], s85 offen lds
    v_pk_fma_f32 v[64:65], v[34:35], v[58:59], v[64:65]
    v_pk_fma_f32 v[66:67], v[36:37], v[58:59], v[66:67]
    v_pk_fma_f32 v[68:69], v[38:39], v[58:59], v[68:69]
    v_pk_fma_f32 v[70:71], v[40:41], v[58:59], v[70:71]
    v_pk_fma_f32 v[72:73], v[42:43], v[58:59], v[72:73]
    v_pk_fma_f32 v[74:75], v[44:45], v[58:59], v[74:75]
    v_pk_fma_f32 v[76:77], v[46:47], v[58:59], v[76:77]
    v_pk_fma_f32 v[78:79], v[48:49], v[58:59], v[78:79]
    s_add_u32 s85, s31, 28672
    s_add_u32 m0, s77, 51200
    s_nop 0
    buffer_load_dwordx4 v182, s[48:51], s85 offen lds
    s_add_u32 s85, s31, 43008
    s_add_u32 m0, s77, 52224
    s_nop 0
    buffer_load_dwordx4 v182, s[48:51], s85 offen lds
    v_pk_fma_f32 v[64:65], v[32:33], v[60:61], v[64:65]
    v_pk_fma_f32 v[66:67], v[34:35], v[60:61], v[66:67]
    v_pk_fma_f32 v[68:69], v[36:37], v[60:61], v[68:69]
    v_pk_fma_f32 v[70:71], v[38:39], v[60:61], v[70:71]
    v_pk_fma_f32 v[72:73], v[40:41], v[60:61], v[72:73]
    v_pk_fma_f32 v[74:75], v[42:43], v[60:61], v[74:75]
    v_pk_fma_f32 v[76:77], v[44:45], v[60:61], v[76:77]
    v_pk_fma_f32 v[78:79], v[46:47], v[60:61], v[78:79]
    s_add_u32 s85, s94, 2
    s_and_b32 s85, s85, 7
    s_lshl_b32 s30, s85, 7
    s_add_u32 s30, s30, s78
    s_mul_i32 s31, s85, 229376
    s_add_u32 s31, s31, s79
    s_add_u32 m0, s77, 65536
    s_nop 0
    buffer_load_dwordx4 v180, s[32:35], s30 offen lds
    s_add_u32 s85, s30, 8192
    s_add_u32 m0, s77, 66560
    s_nop 0
    buffer_load_dwordx4 v181, s[32:35], s85 offen lds
    s_waitcnt lgkmcnt(7)
    v_lshlrev_b32 v80, 16, v20
    v_and_b32 v81, 0xffff0000, v20
    s_waitcnt lgkmcnt(6)
    v_lshlrev_b32 v82, 16, v21
    v_and_b32 v83, 0xffff0000, v21
    s_waitcnt lgkmcnt(5)
    v_lshlrev_b32 v84, 16, v22
    v_and_b32 v85, 0xffff0000, v22
    s_waitcnt lgkmcnt(4)
    v_lshlrev_b32 v86, 16, v23
    v_and_b32 v87, 0xffff0000, v23
    s_waitcnt lgkmcnt(3)
    v_lshlrev_b32 v88, 16, v24
    v_and_b32 v89, 0xffff0000, v24
    s_waitcnt lgkmcnt(2)
    v_lshlrev_b32 v90, 16, v25
    v_and_b32 v91, 0xffff0000, v25
    s_waitcnt lgkmcnt(1)
    v_lshlrev_b32 v92, 16, v26
    v_and_b32 v93, 0xffff0000, v26
    s_waitcnt lgkmcnt(0)
    v_lshlrev_b32 v94, 16, v27
    v_and_b32 v95, 0xffff0000, v27
    s_add_u32 s85, s30, 16384
    s_add_u32 m0, s77, 67584
    s_nop 0
    buffer_load_dwordx4 v180, s[32:35], s85 offen lds
    s_add_u32 s85, s30, 24576
    s_add_u32 m0, s77, 68608
    s_nop 0
    buffer_load_dwordx4 v181, s[32:35], s85 offen lds
    v_pk_mul_f32 v[64:65], v[64:65], v[80:81]
    v_pk_mul_f32 v[66:67], v[66:67], v[82:83]
    v_pk_mul_f32 v[68:69], v[68:69], v[84:85]
    v_pk_mul_f32 v[70:71], v[70:71], v[86:87]
    v_pk_mul_f32 v[72:73], v[72:73], v[88:89]
    v_pk_mul_f32 v[74:75], v[74:75], v[90:91]
    v_pk_mul_f32 v[76:77], v[76:77], v[92:93]
    v_pk_mul_f32 v[78:79], v[78:79], v[94:95]
    v_cvt_pk_bf16_f32 v96, v64, v65
    v_cvt_pk_bf16_f32 v97, v66, v67
    v_cvt_pk_bf16_f32 v98, v68, v69
    v_cvt_pk_bf16_f32 v99, v70, v71
    v_cvt_pk_bf16_f32 v100, v72, v73
    v_cvt_pk_bf16_f32 v101, v74, v75
    v_cvt_pk_bf16_f32 v102, v76, v77
    v_cvt_pk_bf16_f32 v103, v78, v79
    ds_write_b32 v104, v96 offset:0
    ds_write_b32 v104, v97 offset:128
    ds_write_b32 v105, v98 offset:256
    ds_write_b32 v105, v99 offset:384
    ds_write_b32 v106, v100 offset:512
    ds_write_b32 v106, v101 offset:640
    ds_write_b32 v107, v102 offset:768
    ds_write_b32 v107, v103 offset:896
    s_add_u32 m0, s77, 81920
    s_nop 0
    buffer_load_dwordx4 v182, s[48:51], s31 offen lds
    s_add_u32 s85, s31, 14336
    s_add_u32 m0, s77, 82944
    s_nop 0
    buffer_load_dwordx4 v182, s[48:51], s85 offen lds
    s_waitcnt vmcnt(22)
    v_mov_b32 v232, 0
    v_mov_b32 v233, 0
    v_mov_b32 v234, 0
    v_mov_b32 v235, 0
    v_dot2c_f32_bf16 v232, 0x3f803f80, v224
    v_dot2c_f32_bf16 v233, v224, v224
    v_dot2c_f32_bf16 v234, 0x3f803f80, v228
    v_dot2c_f32_bf16 v235, v228, v228
    v_dot2c_f32_bf16 v232, 0x3f803f80, v225
    v_dot2c_f32_bf16 v233, v225, v225
    v_dot2c_f32_bf16 v234, 0x3f803f80, v229
    v_dot2c_f32_bf16 v235, v229, v229
    v_dot2c_f32_bf16 v232, 0x3f803f80, v226
    v_dot2c_f32_bf16 v233, v226, v226
    v_dot2c_f32_bf16 v234, 0x3f803f80, v230
    v_dot2c_f32_bf16 v235, v230, v230
    v_dot2c_f32_bf16 v232, 0x3f803f80, v227
    v_dot2c_f32_bf16 v233, v227, v227
    v_dot2c_f32_bf16 v234, 0x3f803f80, v231
    v_dot2c_f32_bf16 v235, v231, v231
    s_waitcnt lgkmcnt(0)
    s_barrier
    ds_read_b64_tr_b16 v[112:113], v108 offset:4096
    ds_read_b64_tr_b16 v[114:115], v109 offset:4096
    ds_read_b64_tr_b16 v[116:117], v108 offset:0
    ds_read_b64_tr_b16 v[118:119], v109 offset:0
    v_add_f32_dpp v232, v232, v232 row_shr:1 row_mask:0xf bank_mask:0xf
    v_add_f32_dpp v233, v233, v233 row_shr:1 row_mask:0xf bank_mask:0xf
    v_add_f32_dpp v234, v234, v234 row_shr:1 row_mask:0xf bank_mask:0xf
    v_add_f32_dpp v235, v235, v235 row_shr:1 row_mask:0xf bank_mask:0xf
    v_add_f32_dpp v232, v232, v232 row_shr:2 row_mask:0xf bank_mask:0xf
    v_add_f32_dpp v233, v233, v233 row_shr:2 row_mask:0xf bank_mask:0xf
    v_add_f32_dpp v234, v234, v234 row_shr:2 row_mask:0xf bank_mask:0xf
    v_add_f32_dpp v235, v235, v235 row_shr:2 row_mask:0xf bank_mask:0xf
    v_add_f32_dpp v232, v232, v232 row_shr:4 row_mask:0xf bank_mask:0xf
    v_add_f32_dpp v233, v233, v233 row_shr:4 row_mask:0xf bank_mask:0xf
    v_add_f32_dpp v234, v234, v234 row_shr:4 row_mask:0xf bank_mask:0xf
    v_add_f32_dpp v235, v235, v235 row_shr:4 row_mask:0xf bank_mask:0xf
    v_add_f32_dpp v232, v232, v232 row_shr:8 row_mask:0xf bank_mask:0xf
    v_add_f32_dpp v233, v233, v233 row_shr:8 row_mask:0xf bank_mask:0xf
    v_add_f32_dpp v234, v234, v234 row_shr:8 row_mask:0xf bank_mask:0xf
    v_add_f32_dpp v235, v235, v235 row_shr:8 row_mask:0xf bank_mask:0xf
    s_lshl_b32 s80, s73, 18
    s_lshl_b32 s81, s3, 16
    s_add_u32 s80, s80, s81
    s_lshl_b32 s81, s72, 7
    s_sub_u32 s80, s80, s81
    s_add_u32 s80, s80, 1052544
    s_waitcnt lgkmcnt(2)
    buffer_store_dwordx4 v[112:115], v110, s[56:59], s80 offen offset:0 sc1
    s_waitcnt lgkmcnt(0)
    buffer_store_dwordx4 v[116:119], v110, s[56:59], s80 offen offset:64 sc1
    v_add_f32_dpp v232, v232, v232 row_bcast:15 row_mask:0xa bank_mask:0xf
    v_add_f32_dpp v233, v233, v233 row_bcast:15 row_mask:0xa bank_mask:0xf
    v_add_f32_dpp v234, v234, v234 row_bcast:15 row_mask:0xa bank_mask:0xf
    v_add_f32_dpp v235, v235, v235 row_bcast:15 row_mask:0xa bank_mask:0xf
    v_add_f32_dpp v232, v232, v232 row_bcast:31 row_mask:0xc bank_mask:0xf
    v_add_f32_dpp v233, v233, v233 row_bcast:31 row_mask:0xc bank_mask:0xf
    v_add_f32_dpp v234, v234, v234 row_bcast:31 row_mask:0xc bank_mask:0xf
    v_add_f32_dpp v235, v235, v235 row_bcast:31 row_mask:0xc bank_mask:0xf
    s_mov_b32 s100, 0x3b000000
    v_mul_f32 v232, s100, v232
    v_mul_f32 v233, s100, v233
    v_mul_f32 v234, s100, v234
    v_mul_f32 v235, s100, v235
    v_fma_f32 v233, -v232, v232, v233
    v_fma_f32 v235, -v234, v234, v235
    v_max_f32 v233, 0, v233
    v_max_f32 v235, 0, v235
    v_add_f32 v233, 0x3727c5ac, v233
    v_add_f32 v235, 0x3727c5ac, v235
    v_rsq_f32 v233, v233
    v_rsq_f32 v235, v235
    s_lshl_b32 s80, s2, 6
    s_lshl_b32 s81, s3, 4
    s_add_u32 s80, s80, s81
    s_add_u32 s80, s80, 131072
    v_mov_b32 v236, 0
    s_mov_b64 s[92:93], exec
    s_lshl_b64 exec, 1, 63
    buffer_store_dwordx2 v[232:233], v236, s[56:59], s80 offen sc1
    buffer_store_dwordx2 v[234:235], v236, s[56:59], s80 offen offset:8 sc1
    s_mov_b64 exec, s[92:93]
    s_cmp_lg_u32 s3, 0
    s_cbranch_scc1 L_w0_4
    v_mov_b32 v251, 0
    buffer_load_dwordx2 v[248:249], v251, s[64:67], 0 offen sc1
L_w0_4:
    s_add_u32 s85, s31, 28672
    s_add_u32 m0, s77, 83968
    s_nop 0
    buffer_load_dwordx4 v182, s[48:51], s85 offen lds
    s_add_u32 s85, s31, 43008
    s_add_u32 m0, s77, 84992
    s_nop 0
    buffer_load_dwordx4 v182, s[48:51], s85 offen lds
    s_waitcnt vmcnt(20)
    s_waitcnt lgkmcnt(0)
    s_barrier
    ds_read_b64_tr_b16 v[128:129], v176 offset:0
    ds_read_b64_tr_b16 v[130:131], v176 offset:1024
    ds_read_b128 v[136:139], v168 offset:0
    ds_read_b128 v[140:143], v168 offset:4096
    ds_read_b64_tr_b16 v[132:133], v177 offset:0
    ds_read_b64_tr_b16 v[134:135], v177 offset:1024
    s_waitcnt lgkmcnt(3)
    v_mfma_f32_32x32x16_bf16 v[64:79], v[128:131], v[136:139], 0
    ds_read_b64_tr_b16 v[144:145], v176 offset:4096
    ds_read_b64_tr_b16 v[146:147], v176 offset:5120
    ds_read_b128 v[152:155], v169 offset:0
    s_waitcnt lgkmcnt(5)
    v_mfma_f32_32x32x16_bf16 v[80:95], v[128:131], v[140:143], 0
    ds_read_b128 v[156:159], v169 offset:4096
    ds_read_b64_tr_b16 v[148:149], v177 offset:4096
    ds_read_b64_tr_b16 v[150:151], v177 offset:5120
    s_waitcnt lgkmcnt(6)
    v_mfma_f32_32x32x16_bf16 v[96:111], v[132:135], v[136:139], 0
    s_add_u32 s85, s94, 3
    s_and_b32 s85, s85, 7
    s_lshl_b32 s30, s85, 7
    s_add_u32 s30, s30, s78
    s_mul_i32 s31, s85, 229376
    s_add_u32 s31, s31, s79
    s_add_u32 m0, s77, 98304
    s_nop 0
    buffer_load_dwordx4 v180, s[32:35], s30 offen lds
    v_mfma_f32_32x32x16_bf16 v[112:127], v[132:135], v[140:143], 0
    v_mfma_f32_16x16x32_bf16 v[160:163], v[164:167], v[128:131], 0
    s_add_u32 s85, s30, 8192
    s_add_u32 m0, s77, 99328
    s_nop 0
    buffer_load_dwordx4 v181, s[32:35], s85 offen lds
    s_waitcnt lgkmcnt(3)
    v_mfma_f32_32x32x16_bf16 v[64:79], v[144:147], v[152:155], v[64:79]
    ds_read_b64_tr_b16 v[128:129], v176 offset:8192
    ds_read_b64_tr_b16 v[130:131], v176 offset:9216
    ds_read_b128 v[136:139], v170 offset:0
    s_waitcnt lgkmcnt(5)
    v_mfma_f32_32x32x16_bf16 v[80:95], v[144:147], v[156:159], v[80:95]
    ds_read_b128 v[140:143], v170 offset:4096
    ds_read_b64_tr_b16 v[132:133], v177 offset:8192
    ds_read_b64_tr_b16 v[134:135], v177 offset:9216
    s_waitcnt lgkmcnt(6)
    v_mfma_f32_32x32x16_bf16 v[96:111], v[148:151], v[152:155], v[96:111]
    s_add_u32 s85, s30, 16384
    s_add_u32 m0, s77, 100352
    s_nop 0
    buffer_load_dwordx4 v180, s[32:35], s85 offen lds
    v_mfma_f32_32x32x16_bf16 v[112:127], v[148:151], v[156:159], v[112:127]
    v_mfma_f32_16x16x32_bf16 v[160:163], v[164:167], v[144:147], v[160:163]
    s_add_u32 s85, s30, 24576
    s_add_u32 m0, s77, 101376
    s_nop 0
    buffer_load_dwordx4 v181, s[32:35], s85 offen lds
    s_waitcnt lgkmcnt(3)
    v_mfma_f32_32x32x16_bf16 v[64:79], v[128:131], v[136:139], v[64:79]
    ds_read_b64_tr_b16 v[144:145], v176 offset:12288
    ds_read_b64_tr_b16 v[146:147], v176 offset:13312
    ds_read_b128 v[152:155], v171 offset:0
    s_waitcnt lgkmcnt(5)
    v_mfma_f32_32x32x16_bf16 v[80:95], v[128:131], v[140:143], v[80:95]
    ds_read_b128 v[156:159], v171 offset:4096
    ds_read_b64_tr_b16 v[148:149], v177 offset:12288
    ds_read_b64_tr_b16 v[150:151], v177 offset:13312
    s_waitcnt lgkmcnt(6)
    v_mfma_f32_32x32x16_bf16 v[96:111], v[132:135], v[136:139], v[96:111]
    s_add_u32 m0, s77, 114688
    s_nop 0
    buffer_load_dwordx4 v182, s[48:51], s31 offen lds
    v_mfma_f32_32x32x16_bf16 v[112:127], v[132:135], v[140:143], v[112:127]
    v_mfma_f32_16x16x32_bf16 v[160:163], v[164:167], v[128:131], v[160:163]
    s_add_u32 s85, s31, 14336
    s_add_u32 m0, s77, 115712
    s_nop 0
    buffer_load_dwordx4 v182, s[48:51], s85 offen lds
    s_waitcnt lgkmcnt(3)
    v_mfma_f32_32x32x16_bf16 v[64:79], v[144:147], v[152:155], v[64:79]
    s_waitcnt lgkmcnt(0)
    s_waitcnt vmcnt(18)
    s_barrier
    ds_read_b64_tr_b16 v[128:129], v176 offset:32768
    ds_read_b64_tr_b16 v[130:131], v176 offset:33792
    ds_read_b128 v[136:139], v168 offset:32768
    v_mfma_f32_32x32x16_bf16 v[80:95], v[144:147], v[156:159], v[80:95]
    ds_read_b128 v[140:143], v168 offset:36864
    ds_read_b64_tr_b16 v[132:133], v177 offset:32768
    ds_read_b64_tr_b16 v[134:135], v177 offset:33792
    v_mfma_f32_32x32x16_bf16 v[96:111], v[148:151], v[152:155], v[96:111]
    s_add_u32 s85, s31, 28672
    s_add_u32 m0, s77, 116736
    s_nop 0
    buffer_load_dwordx4 v182, s[48:51], s85 offen lds
    v_mfma_f32_32x32x16_bf16 v[112:127], v[148:151], v[156:159], v[112:127]
    v_mfma_f32_16x16x32_bf16 v[160:163], v[164:167], v[144:147], v[160:163]
    s_add_u32 s85, s31, 43008
    s_add_u32 m0, s77, 117760
    s_nop 0
    buffer_load_dwordx4 v182, s[48:51], s85 offen lds
    s_waitcnt lgkmcnt(3)
    v_mfma_f32_32x32x16_bf16 v[64:79], v[128:131], v[136:139], v[64:79]
    ds_read_b64_tr_b16 v[144:145], v176 offset:36864
    ds_read_b64_tr_b16 v[146:147], v176 offset:37888
    ds_read_b128 v[152:155], v169 offset:32768
    s_waitcnt lgkmcnt(5)
    v_mfma_f32_32x32x16_bf16 v[80:95], v[128:131], v[140:143], v[80:95]
    ds_read_b128 v[156:159], v169 offset:36864
    ds_read_b64_tr_b16 v[148:149], v177 offset:36864
    ds_read_b64_tr_b16 v[150:151], v177 offset:37888
    s_waitcnt lgkmcnt(6)
    v_mfma_f32_32x32x16_bf16 v[96:111], v[132:135], v[136:139], v[96:111]
    s_add_u32 s85, s94, 4
    s_and_b32 s85, s85, 7
    s_lshl_b32 s30, s85, 7
    s_add_u32 s30, s30, s78
    s_mul_i32 s31, s85, 229376
    s_add_u32 s31, s31, s79
    s_add_u32 m0, s77, 0
    s_nop 0
    buffer_load_dwordx4 v180, s[32:35], s30 offen lds
    v_mfma_f32_32x32x16_bf16 v[112:127], v[132:135], v[140:143], v[112:127]
    v_mfma_f32_16x16x32_bf16 v[160:163], v[164:167], v[128:131], v[160:163]
    s_add_u32 s85, s30, 8192
    s_add_u32 m0, s77, 1024
    s_nop 0
    buffer_load_dwordx4 v181, s[32:35], s85 offen lds
    s_waitcnt lgkmcnt(3)
    v_mfma_f32_32x32x16_bf16 v[64:79], v[144:147], v[152:155], v[64:79]
    ds_read_b64_tr_b16 v[128:129], v176 offset:40960
    ds_read_b64_tr_b16 v[130:131], v176 offset:41984
    ds_read_b128 v[136:139], v170 offset:32768
    s_waitcnt lgkmcnt(5)
    v_mfma_f32_32x32x16_bf16 v[80:95], v[144:147], v[156:159], v[80:95]
    ds_read_b128 v[140:143], v170 offset:36864
    ds_read_b64_tr_b16 v[132:133], v177 offset:40960
    ds_read_b64_tr_b16 v[134:135], v177 offset:41984
    s_waitcnt lgkmcnt(6)
    v_mfma_f32_32x32x16_bf16 v[96:111], v[148:151], v[152:155], v[96:111]
    s_add_u32 s85, s30, 16384
    s_add_u32 m0, s77, 2048
    s_nop 0
    buffer_load_dwordx4 v180, s[32:35], s85 offen lds
    v_mfma_f32_32x32x16_bf16 v[112:127], v[148:151], v[156:159], v[112:127]
    v_mfma_f32_16x16x32_bf16 v[160:163], v[164:167], v[144:147], v[160:163]
    s_add_u32 s85, s30, 24576
    s_add_u32 m0, s77, 3072
    s_nop 0
    buffer_load_dwordx4 v181, s[32:35], s85 offen lds
    s_waitcnt lgkmcnt(3)
    v_mfma_f32_32x32x16_bf16 v[64:79], v[128:131], v[136:139], v[64:79]
    ds_read_b64_tr_b16 v[144:145], v176 offset:45056
    ds_read_b64_tr_b16 v[146:147], v176 offset:46080
    ds_read_b128 v[152:155], v171 offset:32768
    s_waitcnt lgkmcnt(5)
    v_mfma_f32_32x32x16_bf16 v[80:95], v[128:131], v[140:143], v[80:95]
    ds_read_b128 v[156:159], v171 offset:36864
    ds_read_b64_tr_b16 v[148:149], v177 offset:45056
    ds_read_b64_tr_b16 v[150:151], v177 offset:46080
    s_waitcnt lgkmcnt(6)
    v_mfma_f32_32x32x16_bf16 v[96:111], v[132:135], v[136:139], v[96:111]
    s_add_u32 m0, s77, 16384
    s_nop 0
    buffer_load_dwordx4 v182, s[48:51], s31 offen lds
    v_mfma_f32_32x32x16_bf16 v[112:127], v[132:135], v[140:143], v[112:127]
    v_mfma_f32_16x16x32_bf16 v[160:163], v[164:167], v[128:131], v[160:163]
    s_add_u32 s85, s31, 14336
    s_add_u32 m0, s77, 17408
    s_nop 0
    buffer_load_dwordx4 v182, s[48:51], s85 offen lds
    s_waitcnt lgkmcnt(3)
    v_mfma_f32_32x32x16_bf16 v[64:79], v[144:147], v[152:155], v[64:79]
    s_waitcnt lgkmcnt(0)
    s_waitcnt vmcnt(14)
    s_barrier
    ds_read_b64_tr_b16 v[128:129], v178 offset:0
    ds_read_b64_tr_b16 v[130:131], v178 offset:1024
    ds_read_b128 v[136:139], v172 offset:0
    v_mfma_f32_32x32x16_bf16 v[80:95], v[144:147], v[156:159], v[80:95]
    ds_read_b128 v[140:143], v172 offset:4096
    ds_read_b64_tr_b16 v[132:133], v179 offset:0
    ds_read_b64_tr_b16 v[134:135], v179 offset:1024
    v_mfma_f32_32x32x16_bf16 v[96:111], v[148:151], v[152:155], v[96:111]
    s_add_u32 s85, s31, 28672
    s_add_u32 m0, s77, 18432
    s_nop 0
    buffer_load_dwordx4 v182, s[48:51], s85 offen lds
    v_mfma_f32_32x32x16_bf16 v[112:127], v[148:151], v[156:159], v[112:127]
    v_mfma_f32_16x16x32_bf16 v[160:163], v[164:167], v[144:147], v[160:163]
    s_add_u32 s85, s31, 43008
    s_add_u32 m0, s77, 19456
    s_nop 0
    buffer_load_dwordx4 v182, s[48:51], s85 offen lds
    s_waitcnt lgkmcnt(3)
    v_mfma_f32_32x32x16_bf16 v[64:79], v[128:131], v[136:139], v[64:79]
    ds_read_b64_tr_b16 v[144:145], v178 offset:4096
    ds_read_b64_tr_b16 v[146:147], v178 offset:5120
    ds_read_b128 v[152:155], v173 offset:0
    s_waitcnt lgkmcnt(5)
    v_mfma_f32_32x32x16_bf16 v[80:95], v[128:131], v[140:143], v[80:95]
    ds_read_b128 v[156:159], v173 offset:4096
    ds_read_b64_tr_b16 v[148:149], v179 offset:4096
    ds_read_b64_tr_b16 v[150:151], v179 offset:5120
    s_waitcnt lgkmcnt(6)
    v_mfma_f32_32x32x16_bf16 v[96:111], v[132:135], v[136:139], v[96:111]
    s_add_u32 s85, s94, 5
    s_and_b32 s85, s85, 7
    s_lshl_b32 s30, s85, 7
    s_add_u32 s30, s30, s78
    s_mul_i32 s31, s85, 229376
    s_add_u32 s31, s31, s79
    s_add_u32 m0, s77, 32768
    s_nop 0
    buffer_load_dwordx4 v180, s[32:35], s30 offen lds
    v_mfma_f32_32x32x16_bf16 v[112:127], v[132:135], v[140:143], v[112:127]
    v_mfma_f32_16x16x32_bf16 v[160:163], v[164:167], v[128:131], v[160:163]
    s_add_u32 s85, s30, 8192
    s_add_u32 m0, s77, 33792
    s_nop 0
    buffer_load_dwordx4 v181, s[32:35], s85 offen lds
    s_waitcnt lgkmcnt(3)
    v_mfma_f32_32x32x16_bf16 v[64:79], v[144:147], v[152:155], v[64:79]
    ds_read_b64_tr_b16 v[128:129], v178 offset:8192
    ds_read_b64_tr_b16 v[130:131], v178 offset:9216
    ds_read_b128 v[136:139], v174 offset:0
    s_waitcnt lgkmcnt(5)
    v_mfma_f32_32x32x16_bf16 v[80:95], v[144:147], v[156:159], v[80:95]
    ds_read_b128 v[140:143], v174 offset:4096
    ds_read_b64_tr_b16 v[132:133], v179 offset:8192
    ds_read_b64_tr_b16 v[134:135], v179 offset:9216
    s_waitcnt lgkmcnt(6)
    v_mfma_f32_32x32x16_bf16 v[96:111], v[148:151], v[152:155], v[96:111]
    s_add_u32 s85, s30, 16384
    s_add_u32 m0, s77, 34816
    s_nop 0
    buffer_load_dwordx4 v180, s[32:35], s85 offen lds
    v_mfma_f32_32x32x16_bf16 v[112:127], v[148:151], v[156:159], v[112:127]
    v_mfma_f32_16x16x32_bf16 v[160:163], v[164:167], v[144:147], v[160:163]
    s_add_u32 s85, s30, 24576
    s_add_u32 m0, s77, 35840
    s_nop 0
    buffer_load_dwordx4 v181, s[32:35], s85 offen lds
    s_waitcnt lgkmcnt(3)
    v_mfma_f32_32x32x16_bf16 v[64:79], v[128:131], v[136:139], v[64:79]
    ds_read_b64_tr_b16 v[144:145], v178 offset:12288
    ds_read_b64_tr_b16 v[146:147], v178 offset:13312
    ds_read_b128 v[152:155], v175 offset:0
    s_waitcnt lgkmcnt(5)
    v_mfma_f32_32x32x16_bf16 v[80:95], v[128:131], v[140:143], v[80:95]
    ds_read_b128 v[156:159], v175 offset:4096
    ds_read_b64_tr_b16 v[148:149], v179 offset:12288
    ds_read_b64_tr_b16 v[150:151], v179 offset:13312
    s_waitcnt lgkmcnt(6)
    v_mfma_f32_32x32x16_bf16 v[96:111], v[132:135], v[136:139], v[96:111]
    s_add_u32 m0, s77, 49152
    s_nop 0
    buffer_load_dwordx4 v182, s[48:51], s31 offen lds
    v_mfma_f32_32x32x16_bf16 v[112:127], v[132:135], v[140:143], v[112:127]
    v_mfma_f32_16x16x32_bf16 v[160:163], v[164:167], v[128:131], v[160:163]
    s_add_u32 s85, s31, 14336
    s_add_u32 m0, s77, 50176
    s_nop 0
    buffer_load_dwordx4 v182, s[48:51], s85 offen lds
    s_waitcnt lgkmcnt(3)
    v_mfma_f32_32x32x16_bf16 v[64:79], v[144:147], v[152:155], v[64:79]
    s_waitcnt lgkmcnt(0)
    s_waitcnt vmcnt(14)
    s_barrier
    s_cmp_lg_u32 s3, 0
    s_cbranch_scc1 L_w0_5
    s_mov_b32 s95, 0
L_nonce_6:
    v_readfirstlane_b32 s90, v248
    v_readfirstlane_b32 s91, v249
    s_add_u32 s95, s95, 1
    s_cmp_ge_u32 s95, 0x40000
    s_cbranch_scc1 L_nonce_done_7
    s_cmp_lg_u32 s90, 0
    s_cbranch_scc1 L_nonce_done_7
    buffer_load_dwordx2 v[248:249], v251, s[64:67], 0 offen sc1
    s_waitcnt vmcnt(0)
    s_branch L_nonce_6
L_nonce_done_7:
    s_lshl_b32 s80, s2, 7
    v_mov_b32 v247, s80
    v_mov_b32 v244, s90
    v_mov_b32 v245, s91
    s_mov_b64 s[92:93], exec
    s_mov_b64 exec, 1
    buffer_store_dwordx2 v[244:245], v247, s[56:59], 0 offen sc1
    s_mov_b64 exec, s[92:93]
L_w0_5:
    ds_read_b64_tr_b16 v[128:129], v178 offset:32768
    ds_read_b64_tr_b16 v[130:131], v178 offset:33792
    ds_read_b128 v[136:139], v172 offset:32768
    v_mfma_f32_32x32x16_bf16 v[80:95], v[144:147], v[156:159], v[80:95]
    ds_read_b128 v[140:143], v172 offset:36864
    ds_read_b64_tr_b16 v[132:133], v179 offset:32768
    ds_read_b64_tr_b16 v[134:135], v179 offset:33792
    v_mfma_f32_32x32x16_bf16 v[96:111], v[148:151], v[152:155], v[96:111]
    s_add_u32 s85, s31, 28672
    s_add_u32 m0, s77, 51200
    s_nop 0
    buffer_load_dwordx4 v182, s[48:51], s85 offen lds
    v_mfma_f32_32x32x16_bf16 v[112:127], v[148:151], v[156:159], v[112:127]
    v_mfma_f32_16x16x32_bf16 v[160:163], v[164:167], v[144:147], v[160:163]
    s_add_u32 s85, s31, 43008
    s_add_u32 m0, s77, 52224
    s_nop 0
    buffer_load_dwordx4 v182, s[48:51], s85 offen lds
    s_waitcnt lgkmcnt(3)
    v_mfma_f32_32x32x16_bf16 v[64:79], v[128:131], v[136:139], v[64:79]
    ds_read_b64_tr_b16 v[144:145], v178 offset:36864
    ds_read_b64_tr_b16 v[146:147], v178 offset:37888
    ds_read_b128 v[152:155], v173 offset:32768
    s_waitcnt lgkmcnt(5)
    v_mfma_f32_32x32x16_bf16 v[80:95], v[128:131], v[140:143], v[80:95]
    ds_read_b128 v[156:159], v173 offset:36864
    ds_read_b64_tr_b16 v[148:149], v179 offset:36864
    ds_read_b64_tr_b16 v[150:151], v179 offset:37888
    s_waitcnt lgkmcnt(6)
    v_mfma_f32_32x32x16_bf16 v[96:111], v[132:135], v[136:139], v[96:111]
    s_add_u32 s85, s94, 6
    s_and_b32 s85, s85, 7
    s_lshl_b32 s30, s85, 7
    s_add_u32 s30, s30, s78
    s_mul_i32 s31, s85, 229376
    s_add_u32 s31, s31, s79
    s_add_u32 m0, s77, 65536
    s_nop 0
    buffer_load_dwordx4 v180, s[32:35], s30 offen lds
    v_mfma_f32_32x32x16_bf16 v[112:127], v[132:135], v[140:143], v[112:127]
    v_mfma_f32_16x16x32_bf16 v[160:163], v[164:167], v[128:131], v[160:163]
    s_add_u32 s85, s30, 8192
    s_add_u32 m0, s77, 66560
    s_nop 0
    buffer_load_dwordx4 v181, s[32:35], s85 offen lds
    s_waitcnt lgkmcnt(3)
    v_mfma_f32_32x32x16_bf16 v[64:79], v[144:147], v[152:155], v[64:79]
    ds_read_b64_tr_b16 v[128:129], v178 offset:40960
    ds_read_b64_tr_b16 v[130:131], v178 offset:41984
    ds_read_b128 v[136:139], v174 offset:32768
    s_waitcnt lgkmcnt(5)
    v_mfma_f32_32x32x16_bf16 v[80:95], v[144:147], v[156:159], v[80:95]
    ds_read_b128 v[140:143], v174 offset:36864
    ds_read_b64_tr_b16 v[132:133], v179 offset:40960
    ds_read_b64_tr_b16 v[134:135], v179 offset:41984
    s_waitcnt lgkmcnt(6)
    v_mfma_f32_32x32x16_bf16 v[96:111], v[148:151], v[152:155], v[96:111]
    s_add_u32 s85, s30, 16384
    s_add_u32 m0, s77, 67584
    s_nop 0
    buffer_load_dwordx4 v180, s[32:35], s85 offen lds
    v_mfma_f32_32x32x16_bf16 v[112:127], v[148:151], v[156:159], v[112:127]
    v_mfma_f32_16x16x32_bf16 v[160:163], v[164:167], v[144:147], v[160:163]
    s_add_u32 s85, s30, 24576
    s_add_u32 m0, s77, 68608
    s_nop 0
    buffer_load_dwordx4 v181, s[32:35], s85 offen lds
    s_waitcnt lgkmcnt(3)
    v_mfma_f32_32x32x16_bf16 v[64:79], v[128:131], v[136:139], v[64:79]
    ds_read_b64_tr_b16 v[144:145], v178 offset:45056
    ds_read_b64_tr_b16 v[146:147], v178 offset:46080
    ds_read_b128 v[152:155], v175 offset:32768
    s_waitcnt lgkmcnt(5)
    v_mfma_f32_32x32x16_bf16 v[80:95], v[128:131], v[140:143], v[80:95]
    ds_read_b128 v[156:159], v175 offset:36864
    ds_read_b64_tr_b16 v[148:149], v179 offset:45056
    ds_read_b64_tr_b16 v[150:151], v179 offset:46080
    s_waitcnt lgkmcnt(6)
    v_mfma_f32_32x32x16_bf16 v[96:111], v[132:135], v[136:139], v[96:111]
    s_add_u32 m0, s77, 81920
    s_nop 0
    buffer_load_dwordx4 v182, s[48:51], s31 offen lds
    v_mfma_f32_32x32x16_bf16 v[112:127], v[132:135], v[140:143], v[112:127]
    v_mfma_f32_16x16x32_bf16 v[160:163], v[164:167], v[128:131], v[160:163]
    s_add_u32 s85, s31, 14336
    s_add_u32 m0, s77, 82944
    s_nop 0
    buffer_load_dwordx4 v182, s[48:51], s85 offen lds
    s_waitcnt lgkmcnt(3)
    v_mfma_f32_32x32x16_bf16 v[64:79], v[144:147], v[152:155], v[64:79]
    s_waitcnt lgkmcnt(0)
    s_waitcnt vmcnt(14)
    s_barrier
    ds_read_b64_tr_b16 v[128:129], v176 offset:0
    ds_read_b64_tr_b16 v[130:131], v176 offset:1024
    ds_read_b128 v[136:139], v168 offset:0
    v_mfma_f32_32x32x16_bf16 v[80:95], v[144:147], v[156:159], v[80:95]
    ds_read_b128 v[140:143], v168 offset:4096
    ds_read_b64_tr_b16 v[132:133], v177 offset:0
    ds_read_b64_tr_b16 v[134:135], v177 offset:1024
    v_mfma_f32_32x32x16_bf16 v[96:111], v[148:151], v[152:155], v[96:111]
    s_add_u32 s85, s31, 28672
    s_add_u32 m0, s77, 83968
    s_nop 0
    buffer_load_dwordx4 v182, s[48:51], s85 offen lds
    v_mfma_f32_32x32x16_bf16 v[112:127], v[148:151], v[156:159], v[112:127]
    v_mfma_f32_16x16x32_bf16 v[160:163], v[164:167], v[144:147], v[160:163]
    s_add_u32 s85, s31, 43008
    s_add_u32 m0, s77, 84992
    s_nop 0
    buffer_load_dwordx4 v182, s[48:51], s85 offen lds
    s_waitcnt lgkmcnt(3)
    v_mfma_f32_32x32x16_bf16 v[64:79], v[128:131], v[136:139], v[64:79]
    ds_read_b64_tr_b16 v[144:145], v176 offset:4096
    ds_read_b64_tr_b16 v[146:147], v176 offset:5120
    ds_read_b128 v[152:155], v169 offset:0
    s_waitcnt lgkmcnt(5)
    v_mfma_f32_32x32x16_bf16 v[80:95], v[128:131], v[140:143], v[80:95]
    ds_read_b128 v[156:159], v169 offset:4096
    ds_read_b64_tr_b16 v[148:149], v177 offset:4096
    ds_read_b64_tr_b16 v[150:151], v177 offset:5120
    s_waitcnt lgkmcnt(6)
    v_mfma_f32_32x32x16_bf16 v[96:111], v[132:135], v[136:139], v[96:111]
    s_add_u32 s85, s94, 7
    s_and_b32 s85, s85, 7
    s_lshl_b32 s30, s85, 7
    s_add_u32 s30, s30, s78
    s_mul_i32 s31, s85, 229376
    s_add_u32 s31, s31, s79
    s_add_u32 m0, s77, 98304
    s_nop 0
    buffer_load_dwordx4 v180, s[32:35], s30 offen lds
    v_mfma_f32_32x32x16_bf16 v[112:127], v[132:135], v[140:143], v[112:127]
    v_mfma_f32_16x16x32_bf16 v[160:163], v[164:167], v[128:131], v[160:163]
    s_add_u32 s85, s30, 8192
    s_add_u32 m0, s77, 99328
    s_nop 0
    buffer_load_dwordx4 v181, s[32:35], s85 offen lds
    s_waitcnt lgkmcnt(3)
    v_mfma_f32_32x32x16_bf16 v[64:79], v[144:147], v[152:155], v[64:79]
    ds_read_b64_tr_b16 v[128:129], v176 offset:8192
    ds_read_b64_tr_b16 v[130:131], v176 offset:9216
    ds_read_b128 v[136:139], v170 offset:0
    s_waitcnt lgkmcnt(5)
    v_mfma_f32_32x32x16_bf16 v[80:95], v[144:147], v[156:159], v[80:95]
    ds_read_b128 v[140:143], v170 offset:4096
    ds_read_b64_tr_b16 v[132:133], v177 offset:8192
    ds_read_b64_tr_b16 v[134:135], v177 offset:9216
    s_waitcnt lgkmcnt(6)
    v_mfma_f32_32x32x16_bf16 v[96:111], v[148:151], v[152:155], v[96:111]
    s_add_u32 s85, s30, 16384
    s_add_u32 m0, s77, 100352
    s_nop 0
    buffer_load_dwordx4 v180, s[32:35], s85 offen lds
    v_mfma_f32_32x32x16_bf16 v[112:127], v[148:151], v[156:159], v[112:127]
    v_mfma_f32_16x16x32_bf16 v[160:163], v[164:167], v[144:147], v[160:163]
    s_add_u32 s85, s30, 24576
    s_add_u32 m0, s77, 101376
    s_nop 0
    buffer_load_dwordx4 v181, s[32:35], s85 offen lds
    s_waitcnt lgkmcnt(3)
    v_mfma_f32_32x32x16_bf16 v[64:79], v[128:131], v[136:139], v[64:79]
    ds_read_b64_tr_b16 v[144:145], v176 offset:12288
    ds_read_b64_tr_b16 v[146:147], v176 offset:13312
    ds_read_b128 v[152:155], v171 offset:0
    s_waitcnt lgkmcnt(5)
    v_mfma_f32_32x32x16_bf16 v[80:95], v[128:131], v[140:143], v[80:95]
    ds_read_b128 v[156:159], v171 offset:4096
    ds_read_b64_tr_b16 v[148:149], v177 offset:12288
    ds_read_b64_tr_b16 v[150:151], v177 offset:13312
    s_waitcnt lgkmcnt(6)
    v_mfma_f32_32x32x16_bf16 v[96:111], v[132:135], v[136:139], v[96:111]
    s_add_u32 m0, s77, 114688
    s_nop 0
    buffer_load_dwordx4 v182, s[48:51], s31 offen lds
    v_mfma_f32_32x32x16_bf16 v[112:127], v[132:135], v[140:143], v[112:127]
    v_mfma_f32_16x16x32_bf16 v[160:163], v[164:167], v[128:131], v[160:163]
    s_add_u32 s85, s31, 14336
    s_add_u32 m0, s77, 115712
    s_nop 0
    buffer_load_dwordx4 v182, s[48:51], s85 offen lds
    s_waitcnt lgkmcnt(3)
    v_mfma_f32_32x32x16_bf16 v[64:79], v[144:147], v[152:155], v[64:79]
    s_waitcnt lgkmcnt(0)
    s_waitcnt vmcnt(14)
    s_barrier
    ds_read_b64_tr_b16 v[128:129], v176 offset:32768
    ds_read_b64_tr_b16 v[130:131], v176 offset:33792
    ds_read_b128 v[136:139], v168 offset:32768
    v_mfma_f32_32x32x16_bf16 v[80:95], v[144:147], v[156:159], v[80:95]
    ds_read_b128 v[140:143], v168 offset:36864
    ds_read_b64_tr_b16 v[132:133], v177 offset:32768
    ds_read_b64_tr_b16 v[134:135], v177 offset:33792
    v_mfma_f32_32x32x16_bf16 v[96:111], v[148:151], v[152:155], v[96:111]
    s_add_u32 s85, s31, 28672
    s_add_u32 m0, s77, 116736
    s_nop 0
    buffer_load_dwordx4 v182, s[48:51], s85 offen lds
    v_mfma_f32_32x32x16_bf16 v[112:127], v[148:151], v[156:159], v[112:127]
    v_mfma_f32_16x16x32_bf16 v[160:163], v[164:167], v[144:147], v[160:163]
    s_add_u32 s85, s31, 43008
    s_add_u32 m0, s77, 117760
    s_nop 0
    buffer_load_dwordx4 v182, s[48:51], s85 offen lds
    s_waitcnt lgkmcnt(3)
    v_mfma_f32_32x32x16_bf16 v[64:79], v[128:131], v[136:139], v[64:79]
    ds_read_b64_tr_b16 v[144:145], v176 offset:36864
    ds_read_b64_tr_b16 v[146:147], v176 offset:37888
    ds_read_b128 v[152:155], v169 offset:32768
    s_waitcnt lgkmcnt(5)
    v_mfma_f32_32x32x16_bf16 v[80:95], v[128:131], v[140:143], v[80:95]
    ds_read_b128 v[156:159], v169 offset:36864
    ds_read_b64_tr_b16 v[148:149], v177 offset:36864
    ds_read_b64_tr_b16 v[150:151], v177 offset:37888
    s_waitcnt lgkmcnt(6)
    v_mfma_f32_32x32x16_bf16 v[96:111], v[132:135], v[136:139], v[96:111]
    s_mul_i32 s84, s86, 8960
    s_mul_i32 s85, s87, 4368
    s_add_u32 s101, s84, s85
    s_lshl_b32 s84, s87, 1
    s_sub_u32 s84, s84, 250
    v_lshl_add_u32 v200, v1, 4, s84
    v_mfma_f32_32x32x16_bf16 v[112:127], v[132:135], v[140:143], v[112:127]
    v_mfma_f32_16x16x32_bf16 v[160:163], v[164:167], v[128:131], v[160:163]
    s_add_u32 m0, s101, 0
    s_nop 0
    buffer_load_dwordx4 v200, s[44:47], 0 offen lds
    s_waitcnt lgkmcnt(3)
    v_mfma_f32_32x32x16_bf16 v[64:79], v[144:147], v[152:155], v[64:79]
    ds_read_b64_tr_b16 v[128:129], v176 offset:40960
    ds_read_b64_tr_b16 v[130:131], v176 offset:41984
    ds_read_b128 v[136:139], v170 offset:32768
    s_waitcnt lgkmcnt(5)
    v_mfma_f32_32x32x16_bf16 v[80:95], v[144:147], v[156:159], v[80:95]
    ds_read_b128 v[140:143], v170 offset:36864
    ds_read_b64_tr_b16 v[132:133], v177 offset:40960
    ds_read_b64_tr_b16 v[134:135], v177 offset:41984
    s_waitcnt lgkmcnt(6)
    v_mfma_f32_32x32x16_bf16 v[96:111], v[148:151], v[152:155], v[96:111]
    v_add_u32 v200, 1024, v200
    s_add_u32 m0, s101, 1024
    s_nop 0
    buffer_load_dwordx4 v200, s[44:47], 0 offen lds
    v_mfma_f32_32x32x16_bf16 v[112:127], v[148:151], v[156:159], v[112:127]
    v_mfma_f32_16x16x32_bf16 v[160:163], v[164:167], v[144:147], v[160:163]
    v_add_u32 v200, 1024, v200
    s_add_u32 m0, s101, 2048
    s_nop 0
    buffer_load_dwordx4 v200, s[44:47], 0 offen lds
    s_waitcnt lgkmcnt(3)
    v_mfma_f32_32x32x16_bf16 v[64:79], v[128:131], v[136:139], v[64:79]
    ds_read_b64_tr_b16 v[144:145], v176 offset:45056
    ds_read_b64_tr_b16 v[146:147], v176 offset:46080
    ds_read_b128 v[152:155], v171 offset:32768
    s_waitcnt lgkmcnt(5)
    v_mfma_f32_32x32x16_bf16 v[80:95], v[128:131], v[140:143], v[80:95]
    ds_read_b128 v[156:159], v171 offset:36864
    ds_read_b64_tr_b16 v[148:149], v177 offset:45056
    ds_read_b64_tr_b16 v[150:151], v177 offset:46080
    s_waitcnt lgkmcnt(6)
    v_mfma_f32_32x32x16_bf16 v[96:111], v[132:135], v[136:139], v[96:111]
    v_add_u32 v200, 1024, v200
    s_add_u32 m0, s101, 3072
    s_nop 0
    buffer_load_dwordx4 v200, s[44:47], 0 offen lds
    v_mfma_f32_32x32x16_bf16 v[112:127], v[132:135], v[140:143], v[112:127]
    v_mfma_f32_16x16x32_bf16 v[160:163], v[164:167], v[128:131], v[160:163]
    v_add_u32 v200, 1024, v200
    s_mov_b64 s[92:93], exec
    s_mov_b64 exec, 0xffff
    s_add_u32 m0, s101, 4096
    s_nop 0
    buffer_load_dwordx4 v200, s[44:47], 0 offen lds
    s_mov_b64 exec, s[92:93]
    s_waitcnt lgkmcnt(3)
    v_mfma_f32_32x32x16_bf16 v[64:79], v[144:147], v[152:155], v[64:79]
    s_waitcnt lgkmcnt(0)
    s_waitcnt vmcnt(13)
    s_barrier
    s_cmp_lg_u32 s3, 0
    s_cbranch_scc1 L_w0_8
    v_and_b32 v250, 31, v1
    s_and_b32 s82, s2, 0xe0
    v_add_u32 v250, s82, v250
    v_lshlrev_b32 v250, 7, v250
    v_and_b32 v251, 3, v1
    s_lshl_b32 s82, s73, 2
    v_add_u32 v251, s82, v251
    v_lshlrev_b32 v251, 7, v251
    v_add_u32 v251, 98304, v251
    v_cmp_lt_u32 vcc, 31, v1
    s_nop 1
    v_cndmask_b32 v250, v250, v251, vcc
    v_and_b32 v251, 15, v1
    s_lshl_b32 s82, s74, 4
    v_add_u32 v251, s82, v251
    v_lshlrev_b32 v251, 7, v251
    v_cmp_lt_u32 vcc, 47, v1
    s_nop 1
    v_cndmask_b32 v250, v250, v251, vcc
    buffer_load_dwordx2 v[252:253], v250, s[56:59], 0 offen sc1
L_w0_8:
    ds_read_b64_tr_b16 v[128:129], v178 offset:0
    ds_read_b64_tr_b16 v[130:131], v178 offset:1024
    ds_read_b128 v[136:139], v172 offset:0
    v_mfma_f32_32x32x16_bf16 v[80:95], v[144:147], v[156:159], v[80:95]
    ds_read_b128 v[140:143], v172 offset:4096
    ds_read_b64_tr_b16 v[132:133], v179 offset:0
    ds_read_b64_tr_b16 v[134:135], v179 offset:1024
    v_mfma_f32_32x32x16_bf16 v[96:111], v[148:151], v[152:155], v[96:111]
    s_lshl_b32 s80, s75, 8
    s_lshl_b32 s81, s3, 6
    s_add_u32 s80, s80, s81
    v_and_b32 v183, 31, v1
    v_lshl_add_u32 v183, v183, 1, s80
    global_load_ushort v184, v183, s[20:21]
    v_xor_b32 v183, 64, v183
    global_load_ushort v185, v183, s[20:21]
    v_mfma_f32_32x32x16_bf16 v[112:127], v[148:151], v[156:159], v[112:127]
    v_mfma_f32_16x16x32_bf16 v[160:163], v[164:167], v[144:147], v[160:163]
    v_and_b32 v10, 7, v1
    v_lshrrev_b32 v11, 4, v1
    v_xor_b32 v10, v10, v11
    v_lshrrev_b32 v11, 3, v1
    v_lshlrev_b32 v11, 10, v11
    v_lshl_or_b32 v10, v10, 4, v11
    v_xor_b32 v11, 64, v10
    s_lshl_b32 s80, s72, 16
    s_lshl_b32 s81, s73, 7
    s_add_u32 s80, s80, s81
    s_lshl_b32 s81, s3, 14
    s_add_u32 s80, s80, s81
    s_lshl_b32 s83, s3, 11
    s_add_u32 m0, s83, 139264
    s_nop 0
    buffer_load_dwordx4 v10, s[32:35], s80 offen lds
    s_add_u32 s80, s80, 8192
    s_add_u32 m0, s83, 140288
    s_nop 0
    buffer_load_dwordx4 v11, s[32:35], s80 offen lds
    s_waitcnt lgkmcnt(3)
    v_mfma_f32_32x32x16_bf16 v[64:79], v[128:131], v[136:139], v[64:79]
    ds_read_b64_tr_b16 v[144:145], v178 offset:4096
    ds_read_b64_tr_b16 v[146:147], v178 offset:5120
    ds_read_b128 v[152:155], v173 offset:0
    s_waitcnt lgkmcnt(5)
    v_mfma_f32_32x32x16_bf16 v[80:95], v[128:131], v[140:143], v[80:95]
    ds_read_b128 v[156:159], v173 offset:4096
    ds_read_b64_tr_b16 v[148:149], v179 offset:4096
    ds_read_b64_tr_b16 v[150:151], v179 offset:5120
    s_waitcnt lgkmcnt(6)
    v_mfma_f32_32x32x16_bf16 v[96:111], v[132:135], v[136:139], v[96:111]
    v_mfma_f32_32x32x16_bf16 v[112:127], v[132:135], v[140:143], v[112:127]
    v_mfma_f32_16x16x32_bf16 v[160:163], v[164:167], v[128:131], v[160:163]
    s_waitcnt lgkmcnt(3)
    v_mfma_f32_32x32x16_bf16 v[64:79], v[144:147], v[152:155], v[64:79]
    ds_read_b64_tr_b16 v[128:129], v178 offset:8192
    ds_read_b64_tr_b16 v[130:131], v178 offset:9216
    ds_read_b128 v[136:139], v174 offset:0
    s_waitcnt lgkmcnt(5)
    v_mfma_f32_32x32x16_bf16 v[80:95], v[144:147], v[156:159], v[80:95]
    ds_read_b128 v[140:143], v174 offset:4096
    ds_read_b64_tr_b16 v[132:133], v179 offset:8192
    ds_read_b64_tr_b16 v[134:135], v179 offset:9216
    s_waitcnt lgkmcnt(6)
    v_mfma_f32_32x32x16_bf16 v[96:111], v[148:151], v[152:155], v[96:111]
    v_mfma_f32_32x32x16_bf16 v[112:127], v[148:151], v[156:159], v[112:127]
    v_mfma_f32_16x16x32_bf16 v[160:163], v[164:167], v[144:147], v[160:163]
    s_waitcnt lgkmcnt(3)
    v_mfma_f32_32x32x16_bf16 v[64:79], v[128:131], v[136:139], v[64:79]
    ds_read_b64_tr_b16 v[144:145], v178 offset:12288
    ds_read_b64_tr_b16 v[146:147], v178 offset:13312
    ds_read_b128 v[152:155], v175 offset:0
    s_waitcnt lgkmcnt(5)
    v_mfma_f32_32x32x16_bf16 v[80:95], v[128:131], v[140:143], v[80:95]
    ds_read_b128 v[156:159], v175 offset:4096
    ds_read_b64_tr_b16 v[148:149], v179 offset:12288
    ds_read_b64_tr_b16 v[150:151], v179 offset:13312
    s_waitcnt lgkmcnt(6)
    v_mfma_f32_32x32x16_bf16 v[96:111], v[132:135], v[136:139], v[96:111]
    v_mfma_f32_32x32x16_bf16 v[112:127], v[132:135], v[140:143], v[112:127]
    v_mfma_f32_16x16x32_bf16 v[160:163], v[164:167], v[128:131], v[160:163]
    s_waitcnt lgkmcnt(3)
    v_mfma_f32_32x32x16_bf16 v[64:79], v[144:147], v[152:155], v[64:79]
    s_waitcnt lgkmcnt(0)
    s_waitcnt vmcnt(9)
    s_cmp_lg_u32 s3, 0
    s_cbranch_scc1 L_w0_9
    s_waitcnt vmcnt(4)
    s_mov_b32 s95, 0
L_poll_10:
    v_cmp_ne_u32 vcc, s90, v252
    v_cmp_ne_u32 s[92:93], s91, v253
    s_nop 1
    s_or_b64 vcc, vcc, s[92:93]
    s_cmp_eq_u64 vcc, 0
    s_cbranch_scc1 L_poll_done_11
    s_add_u32 s95, s95, 1
    s_cmp_ge_u32 s95, 0x40000
    s_cbranch_scc1 L_poll_done_11
    buffer_load_dwordx2 v[252:253], v250, s[56:59], 0 offen sc1
    s_waitcnt vmcnt(0)
    s_branch L_poll_10
L_poll_done_11:
L_w0_9:
    s_barrier
    ds_read_b64_tr_b16 v[128:129], v178 offset:32768
    ds_read_b64_tr_b16 v[130:131], v178 offset:33792
    ds_read_b128 v[136:139], v172 offset:32768
    v_mfma_f32_32x32x16_bf16 v[80:95], v[144:147], v[156:159], v[80:95]
    ds_read_b128 v[140:143], v172 offset:36864
    ds_read_b64_tr_b16 v[132:133], v179 offset:32768
    ds_read_b64_tr_b16 v[134:135], v179 offset:33792
    v_mfma_f32_32x32x16_bf16 v[96:111], v[148:151], v[152:155], v[96:111]
    s_lshl_b32 s80, s74, 10
    s_lshl_b32 s81, s87, 9
    s_add_u32 s80, s80, s81
    s_add_u32 s80, s80, 131072
    v_and_b32 v183, 31, v1
    v_lshlrev_b32 v183, 3, v183
    buffer_load_dwordx2 v[186:187], v183, s[56:59], s80 offen sc1
    buffer_load_dwordx2 v[188:189], v183, s[56:59], s80 offen offset:256 sc1
    v_mfma_f32_32x32x16_bf16 v[112:127], v[148:151], v[156:159], v[112:127]
    v_mfma_f32_16x16x32_bf16 v[160:163], v[164:167], v[144:147], v[160:163]
    s_lshl_b32 s80, s89, 12
    s_add_u32 s80, s80, 1048576
    s_add_u32 s68, s28, s80
    s_addc_u32 s69, s29, 0
    s_mov_b32 s70, 4096
    s_mov_b32 s71, 0x00020000
    s_lshl_b32 s81, s87, 2
    s_sub_u32 s81, 4, s81
    v_lshl_add_u32 v208, v1, 4, s81
    s_waitcnt lgkmcnt(3)
    v_mfma_f32_32x32x16_bf16 v[64:79], v[128:131], v[136:139], v[64:79]
    ds_read_b64_tr_b16 v[144:145], v178 offset:36864
    ds_read_b64_tr_b16 v[146:147], v178 offset:37888
    ds_read_b128 v[152:155], v173 offset:32768
    s_waitcnt lgkmcnt(5)
    v_mfma_f32_32x32x16_bf16 v[80:95], v[128:131], v[140:143], v[80:95]
    ds_read_b128 v[156:159], v173 offset:36864
    ds_read_b64_tr_b16 v[148:149], v179 offset:36864
    ds_read_b64_tr_b16 v[150:151], v179 offset:37888
    s_waitcnt lgkmcnt(6)
    v_mfma_f32_32x32x16_bf16 v[96:111], v[132:135], v[136:139], v[96:111]
    buffer_load_dwordx4 v[212:215], v208, s[68:71], 0 offen offset:0 sc1
    v_mfma_f32_32x32x16_bf16 v[112:127], v[132:135], v[140:143], v[112:127]
    v_mfma_f32_16x16x32_bf16 v[160:163], v[164:167], v[128:131], v[160:163]
    buffer_load_dwordx4 v[216:219], v208, s[68:71], 0 offen offset:1024 sc1
    buffer_load_dwordx4 v[220:223], v208, s[68:71], 0 offen offset:2048 sc1
    s_waitcnt lgkmcnt(3)
    v_mfma_f32_32x32x16_bf16 v[64:79], v[144:147], v[152:155], v[64:79]
    ds_read_b64_tr_b16 v[128:129], v178 offset:40960
    ds_read_b64_tr_b16 v[130:131], v178 offset:41984
    ds_read_b128 v[136:139], v174 offset:32768
    s_waitcnt lgkmcnt(5)
    v_mfma_f32_32x32x16_bf16 v[80:95], v[144:147], v[156:159], v[80:95]
    ds_read_b128 v[140:143], v174 offset:36864
    ds_read_b64_tr_b16 v[132:133], v179 offset:40960
    ds_read_b64_tr_b16 v[134:135], v179 offset:41984
    s_waitcnt lgkmcnt(6)
    v_mfma_f32_32x32x16_bf16 v[96:111], v[148:151], v[152:155], v[96:111]
    buffer_load_dwordx4 v[224:227], v208, s[68:71], 0 offen offset:3072 sc1
    v_mfma_f32_32x32x16_bf16 v[112:127], v[148:151], v[156:159], v[112:127]
    v_mfma_f32_16x16x32_bf16 v[160:163], v[164:167], v[144:147], v[160:163]
    s_lshl_b32 s80, s73, 2
    s_add_u32 s80, s80, s3
    s_mul_i32 s80, s80, 57344
    s_add_u32 s80, s80, 12582912
    s_lshl_b32 s81, s86, 10
    s_add_u32 s16, s80, s81
    s_xor_b32 s81, s81, 1024
    s_add_u32 s17, s80, s81
    v_lshlrev_b32 v235, 4, v1
    buffer_load_dwordx4 a[0:3], v235, s[56:59], s16 offen offset:0 sc1
    s_waitcnt lgkmcnt(3)
    v_mfma_f32_32x32x16_bf16 v[64:79], v[128:131], v[136:139], v[64:79]
    ds_read_b64_tr_b16 v[144:145], v178 offset:45056
    ds_read_b64_tr_b16 v[146:147], v178 offset:46080
    ds_read_b128 v[152:155], v175 offset:32768
    s_waitcnt lgkmcnt(5)
    v_mfma_f32_32x32x16_bf16 v[80:95], v[128:131], v[140:143], v[80:95]
    ds_read_b128 v[156:159], v175 offset:36864
    ds_read_b64_tr_b16 v[148:149], v179 offset:45056
    ds_read_b64_tr_b16 v[150:151], v179 offset:46080
    s_waitcnt lgkmcnt(6)
    v_mfma_f32_32x32x16_bf16 v[96:111], v[132:135], v[136:139], v[96:111]
    buffer_load_dwordx4 a[4:7], v235, s[56:59], s17 offen offset:0 sc1
    v_mfma_f32_32x32x16_bf16 v[112:127], v[132:135], v[140:143], v[112:127]
    v_mfma_f32_16x16x32_bf16 v[160:163], v[164:167], v[128:131], v[160:163]
    buffer_load_dwordx4 a[8:11], v235, s[56:59], s16 offen offset:2048 sc1
    buffer_load_dwordx4 a[12:15], v235, s[56:59], s17 offen offset:2048 sc1
    s_waitcnt lgkmcnt(3)
    v_mfma_f32_32x32x16_bf16 v[64:79], v[144:147], v[152:155], v[64:79]
    s_waitcnt lgkmcnt(2)
    v_mfma_f32_32x32x16_bf16 v[80:95], v[144:147], v[156:159], v[80:95]
    s_waitcnt lgkmcnt(0)
    v_mfma_f32_32x32x16_bf16 v[96:111], v[148:151], v[152:155], v[96:111]
    s_add_u32 s16, s16, 4096
    buffer_load_dwordx4 a[16:19], v235, s[56:59], s16 offen offset:0 sc1
    v_mfma_f32_32x32x16_bf16 v[112:127], v[148:151], v[156:159], v[112:127]
    v_mfma_f32_16x16x32_bf16 v[160:163], v[164:167], v[144:147], v[160:163]
    s_add_u32 s17, s17, 4096
    buffer_load_dwordx4 a[20:23], v235, s[56:59], s17 offen offset:0 sc1
    buffer_load_dwordx4 a[24:27], v235, s[56:59], s16 offen offset:2048 sc1
    v_and_b32 v12, 31, v1
    s_lshl_b32 s80, s3, 7
    s_add_u32 s80, s80, 147456
    v_lshl_add_u32 v13, v12, 2, s80
    s_nop 0
    ds_write_b32 v13, v160
    v_xor_b32 v14, 128, v13
    v_cmp_gt_u32 vcc, 32, v1
    s_waitcnt vmcnt(11)
    v_rcp_f32 v22, v187
    v_sub_f32 v23, 0, v186
    v_mul_f32 v30, 0x3fb8aa3b, v187
    v_cvt_pk_bf16_f32 v24, v23, v22
    v_mov_b32 v31, v30
    v_lshlrev_b32 v25, 16, v24
    v_and_b32 v26, 0xffff0000, v24
    v_sub_f32 v25, v23, v25
    v_sub_f32 v26, v22, v26
    v_cvt_pk_bf16_f32 v27, v25, v26
    v_and_b32 v28, 0xffff, v24
    v_lshl_or_b32 v28, v27, 16, v28
    v_lshrrev_b32 v27, 16, v27
    v_cndmask_b32 v136, 0, v28, vcc
    v_cndmask_b32 v137, 0, v24, vcc
    v_cndmask_b32 v138, 0, v27, vcc
    v_mov_b32 v139, 0
    s_waitcnt lgkmcnt(0)
    s_barrier
    ds_read_b32 v17, v14
    v_rcp_f32 v22, v189
    v_sub_f32 v23, 0, v188
    v_mul_f32 v32, 0x3fb8aa3b, v189
    v_cvt_pk_bf16_f32 v24, v23, v22
    v_mov_b32 v33, v32
    v_lshlrev_b32 v25, 16, v24
    v_and_b32 v26, 0xffff0000, v24
    v_sub_f32 v25, v23, v25
    v_sub_f32 v26, v22, v26
    v_cvt_pk_bf16_f32 v27, v25, v26
    v_and_b32 v28, 0xffff, v24
    v_lshl_or_b32 v28, v27, 16, v28
    v_lshrrev_b32 v27, 16, v27
    v_cndmask_b32 v140, 0, v28, vcc
    v_cndmask_b32 v141, 0, v24, vcc
    v_cndmask_b32 v142, 0, v27, vcc
    v_mov_b32 v143, 0
    v_cvt_pk_bf16_f32 v128, v160, v160
    v_and_b32 v22, 0xffff0000, v128
    v_sub_f32 v23, v160, v22
    v_cvt_pk_bf16_f32 v23, v23, v23
    v_and_b32 v23, 0xffff, v23
    v_lshl_or_b32 v129, v184, 16, v23
    v_mov_b32 v130, v184
    v_mov_b32 v131, 0
    s_waitcnt lgkmcnt(0)
    v_cvt_pk_bf16_f32 v132, v17, v17
    v_and_b32 v22, 0xffff0000, v132
    v_sub_f32 v23, v17, v22
    v_cvt_pk_bf16_f32 v23, v23, v23
    v_and_b32 v23, 0xffff, v23
    v_lshl_or_b32 v133, v185, 16, v23
    v_mov_b32 v134, v185
    v_mov_b32 v135, 0
    v_mfma_f32_32x32x16_bf16 v[64:79], v[128:131], v[136:139], v[64:79]
    v_mfma_f32_32x32x16_bf16 v[80:95], v[128:131], v[140:143], v[80:95]
    v_mfma_f32_32x32x16_bf16 v[96:111], v[132:135], v[136:139], v[96:111]
    v_mfma_f32_32x32x16_bf16 v[112:127], v[132:135], v[140:143], v[112:127]
    s_lshl_b32 s80, s74, 2
    s_lshl_b32 s81, s87, 1
    s_add_u32 s80, s80, s81
    s_mul_i32 s80, s80, 112
    s_lshl_b32 s81, s75, 3
    s_add_u32 s80, s80, s81
    s_lshl_b32 s81, s86, 2
    s_add_u32 s80, s80, s81
    s_lshl_b32 s80, s80, 10
    s_add_u32 s98, s80, 5242880
    s_add_u32 s99, s98, 114688
    v_lshlrev_b32 v34, 4, v1
    s_lshl_b32 s80, s87, 11
    v_add_u32 v35, s80, v34
    v_xor_b32 v34, 2048, v35
    v_pk_mul_f32 v[64:65], v[64:65], v[30:31]
    v_pk_mul_f32 v[66:67], v[66:67], v[30:31]
    v_pk_mul_f32 v[68:69], v[68:69], v[30:31]
    v_pk_mul_f32 v[70:71], v[70:71], v[30:31]
    buffer_load_dwordx4 a[28:31], v235, s[56:59], s17 offen offset:2048 sc1
    v_exp_f32 v36, v64
    v_exp_f32 v37, v65
    v_exp_f32 v38, v66
    v_exp_f32 v39, v67
    v_exp_f32 v40, v68
    v_exp_f32 v41, v69
    v_exp_f32 v42, v70
    v_exp_f32 v43, v71
    s_add_u32 s16, s16, 4096
    buffer_load_dwordx4 a[32:35], v235, s[56:59], s16 offen offset:0 sc1
    v_pk_add_f32 v[36:37], v[36:37], 1.0 op_sel_hi:[1,0]
    v_pk_add_f32 v[38:39], v[38:39], 1.0 op_sel_hi:[1,0]
    v_pk_add_f32 v[40:41], v[40:41], 1.0 op_sel_hi:[1,0]
    v_pk_add_f32 v[42:43], v[42:43], 1.0 op_sel_hi:[1,0]
    v_pk_fma_f32 v[36:37], v[36:37], v[36:37], 1.0 op_sel_hi:[1,1,0]
    v_pk_fma_f32 v[38:39], v[38:39], v[38:39], 1.0 op_sel_hi:[1,1,0]
    v_pk_fma_f32 v[40:41], v[40:41], v[40:41], 1.0 op_sel_hi:[1,1,0]
    v_pk_fma_f32 v[42:43], v[42:43], v[42:43], 1.0 op_sel_hi:[1,1,0]
    s_add_u32 s17, s17, 4096
    buffer_load_dwordx4 a[36:39], v235, s[56:59], s17 offen offset:0 sc1
    v_rcp_f32 v36, v36
    v_rcp_f32 v37, v37
    v_rcp_f32 v38, v38
    v_rcp_f32 v39, v39
    v_rcp_f32 v40, v40
    v_rcp_f32 v41, v41
    v_rcp_f32 v42, v42
    v_rcp_f32 v43, v43
    buffer_load_dwordx4 a[40:43], v235, s[56:59], s16 offen offset:2048 sc1
    v_pk_fma_f32 v[36:37], v[36:37], -2.0, 1.0 op_sel_hi:[1,0,0]
    v_pk_fma_f32 v[38:39], v[38:39], -2.0, 1.0 op_sel_hi:[1,0,0]
    v_pk_fma_f32 v[40:41], v[40:41], -2.0, 1.0 op_sel_hi:[1,0,0]
    v_pk_fma_f32 v[42:43], v[42:43], -2.0, 1.0 op_sel_hi:[1,0,0]
    v_pk_mul_f32 v[64:65], v[64:65], v[36:37]
    v_pk_mul_f32 v[66:67], v[66:67], v[38:39]
    v_pk_mul_f32 v[68:69], v[68:69], v[40:41]
    v_pk_mul_f32 v[70:71], v[70:71], v[42:43]
    v_cvt_pk_bf16_f32 v44, v64, v65
    v_cvt_pk_bf16_f32 v45, v66, v67
    v_cvt_pk_bf16_f32 v46, v68, v69
    v_cvt_pk_bf16_f32 v47, v70, v71
    buffer_store_dwordx4 v[44:47], v35, s[56:59], s98 offen offset:0 sc1
    v_pk_mul_f32 v[72:73], v[72:73], v[30:31]
    v_pk_mul_f32 v[74:75], v[74:75], v[30:31]
    v_pk_mul_f32 v[76:77], v[76:77], v[30:31]
    v_pk_mul_f32 v[78:79], v[78:79], v[30:31]
    buffer_load_dwordx4 a[44:47], v235, s[56:59], s17 offen offset:2048 sc1
    v_exp_f32 v36, v72
    v_exp_f32 v37, v73
    v_exp_f32 v38, v74
    v_exp_f32 v39, v75
    v_exp_f32 v40, v76
    v_exp_f32 v41, v77
    v_exp_f32 v42, v78
    v_exp_f32 v43, v79
    s_add_u32 s16, s16, 4096
    buffer_load_dwordx4 a[48:51], v235, s[56:59], s16 offen offset:0 sc1
    v_pk_add_f32 v[36:37], v[36:37], 1.0 op_sel_hi:[1,0]
    v_pk_add_f32 v[38:39], v[38:39], 1.0 op_sel_hi:[1,0]
    v_pk_add_f32 v[40:41], v[40:41], 1.0 op_sel_hi:[1,0]
    v_pk_add_f32 v[42:43], v[42:43], 1.0 op_sel_hi:[1,0]
    v_pk_fma_f32 v[36:37], v[36:37], v[36:37], 1.0 op_sel_hi:[1,1,0]
    v_pk_fma_f32 v[38:39], v[38:39], v[38:39], 1.0 op_sel_hi:[1,1,0]
    v_pk_fma_f32 v[40:41], v[40:41], v[40:41], 1.0 op_sel_hi:[1,1,0]
    v_pk_fma_f32 v[42:43], v[42:43], v[42:43], 1.0 op_sel_hi:[1,1,0]
    s_add_u32 s17, s17, 4096
    buffer_load_dwordx4 a[52:55], v235, s[56:59], s17 offen offset:0 sc1
    v_rcp_f32 v36, v36
    v_rcp_f32 v37, v37
    v_rcp_f32 v38, v38
    v_rcp_f32 v39, v39
    v_rcp_f32 v40, v40
    v_rcp_f32 v41, v41
    v_rcp_f32 v42, v42
    v_rcp_f32 v43, v43
    buffer_load_dwordx4 a[56:59], v235, s[56:59], s16 offen offset:2048 sc1
    v_pk_fma_f32 v[36:37], v[36:37], -2.0, 1.0 op_sel_hi:[1,0,0]
    v_pk_fma_f32 v[38:39], v[38:39], -2.0, 1.0 op_sel_hi:[1,0,0]
    v_pk_fma_f32 v[40:41], v[40:41], -2.0, 1.0 op_sel_hi:[1,0,0]
    v_pk_fma_f32 v[42:43], v[42:43], -2.0, 1.0 op_sel_hi:[1,0,0]
    v_pk_mul_f32 v[72:73], v[72:73], v[36:37]
    v_pk_mul_f32 v[74:75], v[74:75], v[38:39]
    v_pk_mul_f32 v[76:77], v[76:77], v[40:41]
    v_pk_mul_f32 v[78:79], v[78:79], v[42:43]
    v_cvt_pk_bf16_f32 v48, v72, v73
    v_cvt_pk_bf16_f32 v49, v74, v75
    v_cvt_pk_bf16_f32 v50, v76, v77
    v_cvt_pk_bf16_f32 v51, v78, v79
    buffer_store_dwordx4 v[48:51], v35, s[56:59], s98 offen offset:1024 sc1
    v_pk_mul_f32 v[80:81], v[80:81], v[32:33]
    v_pk_mul_f32 v[82:83], v[82:83], v[32:33]
    v_pk_mul_f32 v[84:85], v[84:85], v[32:33]
    v_pk_mul_f32 v[86:87], v[86:87], v[32:33]
    s_mul_i32 s80, s86, 13056
    s_mul_i32 s81, s87, 6528
    s_add_u32 s80, s80, s81
    s_add_u32 s80, s80, 18432
    v_lshrrev_b32 v209, 4, v1
    v_add_u32 v209, v209, v1
    v_lshl_add_u32 v209, v209, 4, s80
    v_lshl_add_u32 v210, v1, 4, s80
    v_mov_b32 v228, 0
    v_mov_b32 v229, 0
    v_mov_b32 v230, 0
    v_mov_b32 v231, 0
    ds_write_b128 v210, v[228:231] offset:4352
    ds_write_b128 v210, v[228:231] offset:5376
    v_exp_f32 v36, v80
    v_exp_f32 v37, v81
    v_exp_f32 v38, v82
    v_exp_f32 v39, v83
    v_exp_f32 v40, v84
    v_exp_f32 v41, v85
    v_exp_f32 v42, v86
    v_exp_f32 v43, v87
    s_waitcnt vmcnt(20)
    ds_write_b128 v209, v[212:215] offset:0
    v_pk_add_f32 v[36:37], v[36:37], 1.0 op_sel_hi:[1,0]
    v_pk_add_f32 v[38:39], v[38:39], 1.0 op_sel_hi:[1,0]
    v_pk_add_f32 v[40:41], v[40:41], 1.0 op_sel_hi:[1,0]
    v_pk_add_f32 v[42:43], v[42:43], 1.0 op_sel_hi:[1,0]
    v_pk_fma_f32 v[36:37], v[36:37], v[36:37], 1.0 op_sel_hi:[1,1,0]
    v_pk_fma_f32 v[38:39], v[38:39], v[38:39], 1.0 op_sel_hi:[1,1,0]
    v_pk_fma_f32 v[40:41], v[40:41], v[40:41], 1.0 op_sel_hi:[1,1,0]
    v_pk_fma_f32 v[42:43], v[42:43], v[42:43], 1.0 op_sel_hi:[1,1,0]
    s_waitcnt vmcnt(19)
    ds_write_b128 v209, v[216:219] offset:1088
    v_rcp_f32 v36, v36
    v_rcp_f32 v37, v37
    v_rcp_f32 v38, v38
    v_rcp_f32 v39, v39
    v_rcp_f32 v40, v40
    v_rcp_f32 v41, v41
    v_rcp_f32 v42, v42
    v_rcp_f32 v43, v43
    s_waitcnt vmcnt(18)
    ds_write_b128 v209, v[220:223] offset:2176
    v_pk_fma_f32 v[36:37], v[36:37], -2.0, 1.0 op_sel_hi:[1,0,0]
    v_pk_fma_f32 v[38:39], v[38:39], -2.0, 1.0 op_sel_hi:[1,0,0]
    v_pk_fma_f32 v[40:41], v[40:41], -2.0, 1.0 op_sel_hi:[1,0,0]
    v_pk_fma_f32 v[42:43], v[42:43], -2.0, 1.0 op_sel_hi:[1,0,0]
    v_pk_mul_f32 v[80:81], v[80:81], v[36:37]
    v_pk_mul_f32 v[82:83], v[82:83], v[38:39]
    v_pk_mul_f32 v[84:85], v[84:85], v[40:41]
    v_pk_mul_f32 v[86:87], v[86:87], v[42:43]
    v_cvt_pk_bf16_f32 v44, v80, v81
    v_cvt_pk_bf16_f32 v45, v82, v83
    v_cvt_pk_bf16_f32 v46, v84, v85
    v_cvt_pk_bf16_f32 v47, v86, v87
    buffer_store_dwordx4 v[44:47], v35, s[56:59], s99 offen offset:0 sc1
    v_pk_mul_f32 v[88:89], v[88:89], v[32:33]
    v_pk_mul_f32 v[90:91], v[90:91], v[32:33]
    v_pk_mul_f32 v[92:93], v[92:93], v[32:33]
    v_pk_mul_f32 v[94:95], v[94:95], v[32:33]
    s_waitcnt vmcnt(18)
    ds_write_b128 v209, v[224:227] offset:3264
    v_exp_f32 v36, v88
    v_exp_f32 v37, v89
    v_exp_f32 v38, v90
    v_exp_f32 v39, v91
    v_exp_f32 v40, v92
    v_exp_f32 v41, v93
    v_exp_f32 v42, v94
    v_exp_f32 v43, v95
    buffer_load_dwordx4 a[60:63], v235, s[56:59], s17 offen offset:2048 sc1
    v_pk_add_f32 v[36:37], v[36:37], 1.0 op_sel_hi:[1,0]
    v_pk_add_f32 v[38:39], v[38:39], 1.0 op_sel_hi:[1,0]
    v_pk_add_f32 v[40:41], v[40:41], 1.0 op_sel_hi:[1,0]
    v_pk_add_f32 v[42:43], v[42:43], 1.0 op_sel_hi:[1,0]
    v_pk_fma_f32 v[36:37], v[36:37], v[36:37], 1.0 op_sel_hi:[1,1,0]
    v_pk_fma_f32 v[38:39], v[38:39], v[38:39], 1.0 op_sel_hi:[1,1,0]
    v_pk_fma_f32 v[40:41], v[40:41], v[40:41], 1.0 op_sel_hi:[1,1,0]
    v_pk_fma_f32 v[42:43], v[42:43], v[42:43], 1.0 op_sel_hi:[1,1,0]
    s_add_u32 s16, s16, 4096
    buffer_load_dwordx4 a[64:67], v235, s[56:59], s16 offen offset:0 sc1
    v_rcp_f32 v36, v36
    v_rcp_f32 v37, v37
    v_rcp_f32 v38, v38
    v_rcp_f32 v39, v39
    v_rcp_f32 v40, v40
    v_rcp_f32 v41, v41
    v_rcp_f32 v42, v42
    v_rcp_f32 v43, v43
    s_add_u32 s17, s17, 4096
    buffer_load_dwordx4 a[68:71], v235, s[56:59], s17 offen offset:0 sc1
    v_pk_fma_f32 v[36:37], v[36:37], -2.0, 1.0 op_sel_hi:[1,0,0]
    v_pk_fma_f32 v[38:39], v[38:39], -2.0, 1.0 op_sel_hi:[1,0,0]
    v_pk_fma_f32 v[40:41], v[40:41], -2.0, 1.0 op_sel_hi:[1,0,0]
    v_pk_fma_f32 v[42:43], v[42:43], -2.0, 1.0 op_sel_hi:[1,0,0]
    v_pk_mul_f32 v[88:89], v[88:89], v[36:37]
    v_pk_mul_f32 v[90:91], v[90:91], v[38:39]
    v_pk_mul_f32 v[92:93], v[92:93], v[40:41]
    v_pk_mul_f32 v[94:95], v[94:95], v[42:43]
    v_cvt_pk_bf16_f32 v48, v88, v89
    v_cvt_pk_bf16_f32 v49, v90, v91
    v_cvt_pk_bf16_f32 v50, v92, v93
    v_cvt_pk_bf16_f32 v51, v94, v95
    buffer_store_dwordx4 v[48:51], v35, s[56:59], s99 offen offset:1024 sc1
    v_pk_mul_f32 v[96:97], v[96:97], v[30:31]
    v_pk_mul_f32 v[98:99], v[98:99], v[30:31]
    v_pk_mul_f32 v[100:101], v[100:101], v[30:31]
    v_pk_mul_f32 v[102:103], v[102:103], v[30:31]
    buffer_load_dwordx4 a[72:75], v235, s[56:59], s16 offen offset:2048 sc1
    v_exp_f32 v36, v96
    v_exp_f32 v37, v97
    v_exp_f32 v38, v98
    v_exp_f32 v39, v99
    v_exp_f32 v40, v100
    v_exp_f32 v41, v101
    v_exp_f32 v42, v102
    v_exp_f32 v43, v103
    buffer_load_dwordx4 a[76:79], v235, s[56:59], s17 offen offset:2048 sc1
    v_pk_add_f32 v[36:37], v[36:37], 1.0 op_sel_hi:[1,0]
    v_pk_add_f32 v[38:39], v[38:39], 1.0 op_sel_hi:[1,0]
    v_pk_add_f32 v[40:41], v[40:41], 1.0 op_sel_hi:[1,0]
    v_pk_add_f32 v[42:43], v[42:43], 1.0 op_sel_hi:[1,0]
    v_pk_fma_f32 v[36:37], v[36:37], v[36:37], 1.0 op_sel_hi:[1,1,0]
    v_pk_fma_f32 v[38:39], v[38:39], v[38:39], 1.0 op_sel_hi:[1,1,0]
    v_pk_fma_f32 v[40:41], v[40:41], v[40:41], 1.0 op_sel_hi:[1,1,0]
    v_pk_fma_f32 v[42:43], v[42:43], v[42:43], 1.0 op_sel_hi:[1,1,0]
    s_add_u32 s16, s16, 4096
    buffer_load_dwordx4 a[80:83], v235, s[56:59], s16 offen offset:0 sc1
    v_rcp_f32 v36, v36
    v_rcp_f32 v37, v37
    v_rcp_f32 v38, v38
    v_rcp_f32 v39, v39
    v_rcp_f32 v40, v40
    v_rcp_f32 v41, v41
    v_rcp_f32 v42, v42
    v_rcp_f32 v43, v43
    s_add_u32 s17, s17, 4096
    buffer_load_dwordx4 a[84:87], v235, s[56:59], s17 offen offset:0 sc1
    v_pk_fma_f32 v[36:37], v[36:37], -2.0, 1.0 op_sel_hi:[1,0,0]
    v_pk_fma_f32 v[38:39], v[38:39], -2.0, 1.0 op_sel_hi:[1,0,0]
    v_pk_fma_f32 v[40:41], v[40:41], -2.0, 1.0 op_sel_hi:[1,0,0]
    v_pk_fma_f32 v[42:43], v[42:43], -2.0, 1.0 op_sel_hi:[1,0,0]
    v_pk_mul_f32 v[96:97], v[96:97], v[36:37]
    v_pk_mul_f32 v[98:99], v[98:99], v[38:39]
    v_pk_mul_f32 v[100:101], v[100:101], v[40:41]
    v_pk_mul_f32 v[102:103], v[102:103], v[42:43]
    v_cvt_pk_bf16_f32 v44, v96, v97
    v_cvt_pk_bf16_f32 v45, v98, v99
    v_cvt_pk_bf16_f32 v46, v100, v101
    v_cvt_pk_bf16_f32 v47, v102, v103
    buffer_store_dwordx4 v[44:47], v34, s[56:59], s98 offen offset:0 sc1
    v_pk_mul_f32 v[104:105], v[104:105], v[30:31]
    v_pk_mul_f32 v[106:107], v[106:107], v[30:31]
    v_pk_mul_f32 v[108:109], v[108:109], v[30:31]
    v_pk_mul_f32 v[110:111], v[110:111], v[30:31]
    buffer_load_dwordx4 a[88:91], v235, s[56:59], s16 offen offset:2048 sc1
    v_exp_f32 v36, v104
    v_exp_f32 v37, v105
    v_exp_f32 v38, v106
    v_exp_f32 v39, v107
    v_exp_f32 v40, v108
    v_exp_f32 v41, v109
    v_exp_f32 v42, v110
    v_exp_f32 v43, v111
    buffer_load_dwordx4 a[92:95], v235, s[56:59], s17 offen offset:2048 sc1
    v_pk_add_f32 v[36:37], v[36:37], 1.0 op_sel_hi:[1,0]
    v_pk_add_f32 v[38:39], v[38:39], 1.0 op_sel_hi:[1,0]
    v_pk_add_f32 v[40:41], v[40:41], 1.0 op_sel_hi:[1,0]
    v_pk_add_f32 v[42:43], v[42:43], 1.0 op_sel_hi:[1,0]
    v_pk_fma_f32 v[36:37], v[36:37], v[36:37], 1.0 op_sel_hi:[1,1,0]
    v_pk_fma_f32 v[38:39], v[38:39], v[38:39], 1.0 op_sel_hi:[1,1,0]
    v_pk_fma_f32 v[40:41], v[40:41], v[40:41], 1.0 op_sel_hi:[1,1,0]
    v_pk_fma_f32 v[42:43], v[42:43], v[42:43], 1.0 op_sel_hi:[1,1,0]
    s_add_u32 s16, s16, 4096
    buffer_load_dwordx4 a[96:99], v235, s[56:59], s16 offen offset:0 sc1
    v_rcp_f32 v36, v36
    v_rcp_f32 v37, v37
    v_rcp_f32 v38, v38
    v_rcp_f32 v39, v39
    v_rcp_f32 v40, v40
    v_rcp_f32 v41, v41
    v_rcp_f32 v42, v42
    v_rcp_f32 v43, v43
    s_add_u32 s17, s17, 4096
    buffer_load_dwordx4 a[100:103], v235, s[56:59], s17 offen offset:0 sc1
    v_pk_fma_f32 v[36:37], v[36:37], -2.0, 1.0 op_sel_hi:[1,0,0]
    v_pk_fma_f32 v[38:39], v[38:39], -2.0, 1.0 op_sel_hi:[1,0,0]
    v_pk_fma_f32 v[40:41], v[40:41], -2.0, 1.0 op_sel_hi:[1,0,0]
    v_pk_fma_f32 v[42:43], v[42:43], -2.0, 1.0 op_sel_hi:[1,0,0]
    v_pk_mul_f32 v[104:105], v[104:105], v[36:37]
    v_pk_mul_f32 v[106:107], v[106:107], v[38:39]
    v_pk_mul_f32 v[108:109], v[108:109], v[40:41]
    v_pk_mul_f32 v[110:111], v[110:111], v[42:43]
    v_cvt_pk_bf16_f32 v48, v104, v105
    v_cvt_pk_bf16_f32 v49, v106, v107
    v_cvt_pk_bf16_f32 v50, v108, v109
    v_cvt_pk_bf16_f32 v51, v110, v111
    buffer_store_dwordx4 v[48:51], v34, s[56:59], s98 offen offset:1024 sc1
    v_pk_mul_f32 v[112:113], v[112:113], v[32:33]
    v_pk_mul_f32 v[114:115], v[114:115], v[32:33]
    v_pk_mul_f32 v[116:117], v[116:117], v[32:33]
    v_pk_mul_f32 v[118:119], v[118:119], v[32:33]
    buffer_load_dwordx4 a[104:107], v235, s[56:59], s16 offen offset:2048 sc1
    v_exp_f32 v36, v112
    v_exp_f32 v37, v113
    v_exp_f32 v38, v114
    v_exp_f32 v39, v115
    v_exp_f32 v40, v116
    v_exp_f32 v41, v117
    v_exp_f32 v42, v118
    v_exp_f32 v43, v119
    buffer_load_dwordx4 a[108:111], v235, s[56:59], s17 offen offset:2048 sc1
    v_pk_add_f32 v[36:37], v[36:37], 1.0 op_sel_hi:[1,0]
    v_pk_add_f32 v[38:39], v[38:39], 1.0 op_sel_hi:[1,0]
    v_pk_add_f32 v[40:41], v[40:41], 1.0 op_sel_hi:[1,0]
    v_pk_add_f32 v[42:43], v[42:43], 1.0 op_sel_hi:[1,0]
    v_pk_fma_f32 v[36:37], v[36:37], v[36:37], 1.0 op_sel_hi:[1,1,0]
    v_pk_fma_f32 v[38:39], v[38:39], v[38:39], 1.0 op_sel_hi:[1,1,0]
    v_pk_fma_f32 v[40:41], v[40:41], v[40:41], 1.0 op_sel_hi:[1,1,0]
    v_pk_fma_f32 v[42:43], v[42:43], v[42:43], 1.0 op_sel_hi:[1,1,0]
    s_add_u32 s16, s16, 4096
    buffer_load_dwordx4 a[112:115], v235, s[56:59], s16 offen offset:0 sc1
    v_rcp_f32 v36, v36
    v_rcp_f32 v37, v37
    v_rcp_f32 v38, v38
    v_rcp_f32 v39, v39
    v_rcp_f32 v40, v40
    v_rcp_f32 v41, v41
    v_rcp_f32 v42, v42
    v_rcp_f32 v43, v43
    s_add_u32 s17, s17, 4096
    buffer_load_dwordx4 a[116:119], v235, s[56:59], s17 offen offset:0 sc1
    v_pk_fma_f32 v[36:37], v[36:37], -2.0, 1.0 op_sel_hi:[1,0,0]
    v_pk_fma_f32 v[38:39], v[38:39], -2.0, 1.0 op_sel_hi:[1,0,0]
    v_pk_fma_f32 v[40:41], v[40:41], -2.0, 1.0 op_sel_hi:[1,0,0]
    v_pk_fma_f32 v[42:43], v[42:43], -2.0, 1.0 op_sel_hi:[1,0,0]
    v_pk_mul_f32 v[112:113], v[112:113], v[36:37]
    v_pk_mul_f32 v[114:115], v[114:115], v[38:39]
    v_pk_mul_f32 v[116:117], v[116:117], v[40:41]
    v_pk_mul_f32 v[118:119], v[118:119], v[42:43]
    v_cvt_pk_bf16_f32 v44, v112, v113
    v_cvt_pk_bf16_f32 v45, v114, v115
    v_cvt_pk_bf16_f32 v46, v116, v117
    v_cvt_pk_bf16_f32 v47, v118, v119
    buffer_store_dwordx4 v[44:47], v34, s[56:59], s99 offen offset:0 sc1
    v_pk_mul_f32 v[120:121], v[120:121], v[32:33]
    v_pk_mul_f32 v[122:123], v[122:123], v[32:33]
    v_pk_mul_f32 v[124:125], v[124:125], v[32:33]
    v_pk_mul_f32 v[126:127], v[126:127], v[32:33]
    buffer_load_dwordx4 a[120:123], v235, s[56:59], s16 offen offset:2048 sc1
    v_exp_f32 v36, v120
    v_exp_f32 v37, v121
    v_exp_f32 v38, v122
    v_exp_f32 v39, v123
    v_exp_f32 v40, v124
    v_exp_f32 v41, v125
    v_exp_f32 v42, v126
    v_exp_f32 v43, v127
    buffer_load_dwordx4 a[124:127], v235, s[56:59], s17 offen offset:2048 sc1
    v_pk_add_f32 v[36:37], v[36:37], 1.0 op_sel_hi:[1,0]
    v_pk_add_f32 v[38:39], v[38:39], 1.0 op_sel_hi:[1,0]
    v_pk_add_f32 v[40:41], v[40:41], 1.0 op_sel_hi:[1,0]
    v_pk_add_f32 v[42:43], v[42:43], 1.0 op_sel_hi:[1,0]
    v_pk_fma_f32 v[36:37], v[36:37], v[36:37], 1.0 op_sel_hi:[1,1,0]
    v_pk_fma_f32 v[38:39], v[38:39], v[38:39], 1.0 op_sel_hi:[1,1,0]
    v_pk_fma_f32 v[40:41], v[40:41], v[40:41], 1.0 op_sel_hi:[1,1,0]
    v_pk_fma_f32 v[42:43], v[42:43], v[42:43], 1.0 op_sel_hi:[1,1,0]
    s_add_u32 s16, s16, 4096
    buffer_load_dwordx4 a[128:131], v235, s[56:59], s16 offen offset:0 sc1
    v_rcp_f32 v36, v36
    v_rcp_f32 v37, v37
    v_rcp_f32 v38, v38
    v_rcp_f32 v39, v39
    v_rcp_f32 v40, v40
    v_rcp_f32 v41, v41
    v_rcp_f32 v42, v42
    v_rcp_f32 v43, v43
    s_add_u32 s17, s17, 4096
    buffer_load_dwordx4 a[132:135], v235, s[56:59], s17 offen offset:0 sc1
    v_pk_fma_f32 v[36:37], v[36:37], -2.0, 1.0 op_sel_hi:[1,0,0]
    v_pk_fma_f32 v[38:39], v[38:39], -2.0, 1.0 op_sel_hi:[1,0,0]
    v_pk_fma_f32 v[40:41], v[40:41], -2.0, 1.0 op_sel_hi:[1,0,0]
    v_pk_fma_f32 v[42:43], v[42:43], -2.0, 1.0 op_sel_hi:[1,0,0]
    v_pk_mul_f32 v[120:121], v[120:121], v[36:37]
    v_pk_mul_f32 v[122:123], v[122:123], v[38:39]
    v_pk_mul_f32 v[124:125], v[124:125], v[40:41]
    v_pk_mul_f32 v[126:127], v[126:127], v[42:43]
    v_cvt_pk_bf16_f32 v48, v120, v121
    v_cvt_pk_bf16_f32 v49, v122, v123
    v_cvt_pk_bf16_f32 v50, v124, v125
    v_cvt_pk_bf16_f32 v51, v126, v127
    buffer_store_dwordx4 v[48:51], v34, s[56:59], s99 offen offset:1024 sc1
    s_lshl_b32 s84, s4, 16
    s_lshr_b32 s85, s4, 16
    s_lshl_b32 s80, s5, 16
    s_or_b32 s85, s85, s80
    s_cmp_eq_u32 s87, 0
    s_cselect_b32 s84, s84, s4
    s_cselect_b32 s85, s85, s5
    v_mov_b32 v204, 0
    v_mov_b32 v205, 0
    v_mov_b32 v206, s84
    v_mov_b32 v207, s85
    s_mul_i32 s84, s86, 8960
    s_mul_i32 s85, s87, 4368
    s_add_u32 s84, s84, s85
    s_add_u32 s84, s84, 240
    v_mov_b32 v203, s84
    s_mov_b64 s[92:93], exec
    s_mov_b64 exec, 1
    ds_write_b128 v203, v[204:207]
    s_mov_b64 exec, s[92:93]
    s_branch L_join
L_helper:
    s_sub_u32 s80, s76, 28
    s_lshl_b32 s80, s80, 3
    s_add_u32 s94, s80, s88
    s_and_b32 s80, s94, 3
    s_mul_i32 s80, s80, 458752
    s_lshr_b32 s81, s94, 2
    s_lshl_b32 s81, s81, 7
    s_add_u32 s80, s80, s81
    s_mul_i32 s81, s3, 114688
    s_add_u32 s30, s80, s81
    s_mul_i32 s31, s3, 14336
    v_and_b32 v180, 7, v1
    v_bfe_u32 v181, v1, 4, 1
    v_lshlrev_b32 v181, 2, v181
    v_xor_b32 v180, v180, v181
    v_lshlrev_b32 v180, 4, v180
    v_lshrrev_b32 v181, 3, v1
    v_lshl_or_b32 v180, v181, 10, v180
    s_add_u32 s85, s30, 0
    s_add_u32 m0, s31, 0
    s_nop 0
    buffer_load_dwordx4 v180, s[52:55], s85 offen lds
    s_add_u32 s85, s30, 8192
    s_add_u32 m0, s31, 1024
    s_nop 0
    buffer_load_dwordx4 v180, s[52:55], s85 offen lds
    s_add_u32 s85, s30, 16384
    s_add_u32 m0, s31, 2048
    s_nop 0
    buffer_load_dwordx4 v180, s[52:55], s85 offen lds
    s_add_u32 s85, s30, 24576
    s_add_u32 m0, s31, 3072
    s_nop 0
    buffer_load_dwordx4 v180, s[52:55], s85 offen lds
    s_add_u32 s85, s30, 32768
    s_add_u32 m0, s31, 4096
    s_nop 0
    buffer_load_dwordx4 v180, s[52:55], s85 offen lds
    s_add_u32 s85, s30, 40960
    s_add_u32 m0, s31, 5120
    s_nop 0
    buffer_load_dwordx4 v180, s[52:55], s85 offen lds
    v_and_b32 v12, 31, v1
    v_lshrrev_b32 v13, 5, v1
    s_lshl_b32 s80, s3, 1
    v_add_u32 v14, s80, v13
    v_lshlrev_b32 v15, 10, v14
    v_lshl_or_b32 v15, v12, 2, v15
    v_add_u32 v16, 98944, v15
    v_add_u32 v17, 107520, v15
    v_lshrrev_b32 v15, 2, v12
    v_lshlrev_b32 v18, 2, v13
    v_xor_b32 v15, v15, v18
    v_lshlrev_b32 v15, 4, v15
    v_and_b32 v18, 3, v12
    v_lshl_or_b32 v15, v18, 2, v15
    v_lshl_or_b32 v15, v14, 10, v15
    v_add_u32 v104, 131072, v15
    v_xor_b32 v105, 16, v104
    v_xor_b32 v106, 32, v104
    v_xor_b32 v107, 48, v104
    v_lshrrev_b32 v12, 4, v1
    v_bfe_u32 v13, v1, 2, 2
    v_lshl_add_u32 v14, v12, 3, v13
    v_sub_u32 v14, 31, v14
    v_bfe_u32 v15, v1, 1, 1
    s_lshl_b32 s80, s3, 1
    v_add_u32 v15, s80, v15
    v_and_b32 v18, 1, v1
    v_bfe_u32 v19, v14, 1, 3
    v_xor_b32 v19, v19, v15
    v_lshlrev_b32 v19, 4, v19
    v_lshl_or_b32 v19, v18, 3, v19
    v_lshl_or_b32 v19, v14, 7, v19
    v_add_u32 v108, 131072, v19
    v_subrev_u32 v14, 4, v14
    v_bfe_u32 v19, v14, 1, 3
    v_xor_b32 v19, v19, v15
    v_lshlrev_b32 v19, 4, v19
    v_lshl_or_b32 v19, v18, 3, v19
    v_lshl_or_b32 v19, v14, 7, v19
    v_add_u32 v109, 131072, v19
    v_and_b32 v110, 15, v1
    v_lshlrev_b32 v110, 12, v110
    v_lshl_or_b32 v110, v12, 4, v110
    s_waitcnt lgkmcnt(0)
    s_waitcnt vmcnt(9)
    s_barrier
    ds_read_b32 v188, v16 offset:0
    ds_read_b32 v189, v16 offset:128
    ds_read_b32 v190, v16 offset:256
    ds_read_b32 v191, v16 offset:384
    ds_read_b32 v192, v16 offset:512
    ds_read_b32 v193, v16 offset:640
    ds_read_b32 v194, v16 offset:768
    ds_read_b32 v195, v16 offset:896
    ds_read_b32 v196, v16 offset:1024
    ds_read_b32 v197, v16 offset:1152
    ds_read_b32 v198, v16 offset:1280
    ds_read_b32 v20, v17 offset:0
    ds_read_b32 v21, v17 offset:128
    ds_read_b32 v22, v17 offset:256
    ds_read_b32 v23, v17 offset:384
    s_waitcnt vmcnt(8)
    v_lshlrev_b32 v54, 16, v28
    v_lshlrev_b32 v55, 16, v30
    v_and_b32 v56, 0xffff0000, v28
    v_and_b32 v57, 0xffff0000, v30
    v_lshlrev_b32 v58, 16, v29
    v_lshlrev_b32 v59, 16, v31
    v_and_b32 v60, 0xffff0000, v29
    v_and_b32 v61, 0xffff0000, v31
    s_waitcnt lgkmcnt(14)
    v_lshlrev_b32 v32, 16, v188
    v_and_b32 v33, 0xffff0000, v188
    s_waitcnt lgkmcnt(13)
    v_lshlrev_b32 v34, 16, v189
    v_and_b32 v35, 0xffff0000, v189
    s_waitcnt lgkmcnt(12)
    v_lshlrev_b32 v36, 16, v190
    v_and_b32 v37, 0xffff0000, v190
    s_waitcnt lgkmcnt(11)
    v_lshlrev_b32 v38, 16, v191
    v_and_b32 v39, 0xffff0000, v191
    ds_read_b32 v24, v17 offset:512
    ds_read_b32 v25, v17 offset:640
    ds_read_b32 v26, v17 offset:768
    ds_read_b32 v27, v17 offset:896
    s_waitcnt lgkmcnt(14)
    v_lshlrev_b32 v40, 16, v192
    v_and_b32 v41, 0xffff0000, v192
    s_waitcnt lgkmcnt(13)
    v_lshlrev_b32 v42, 16, v193
    v_and_b32 v43, 0xffff0000, v193
    s_waitcnt lgkmcnt(12)
    v_lshlrev_b32 v44, 16, v194
    v_and_b32 v45, 0xffff0000, v194
    s_waitcnt lgkmcnt(11)
    v_lshlrev_b32 v46, 16, v195
    v_and_b32 v47, 0xffff0000, v195
    s_waitcnt lgkmcnt(10)
    v_lshlrev_b32 v48, 16, v196
    v_and_b32 v49, 0xffff0000, v196
    s_waitcnt lgkmcnt(9)
    v_lshlrev_b32 v50, 16, v197
    v_and_b32 v51, 0xffff0000, v197
    s_waitcnt lgkmcnt(8)
    v_lshlrev_b32 v52, 16, v198
    v_and_b32 v53, 0xffff0000, v198
    s_add_u32 s85, s30, 49152
    s_add_u32 m0, s31, 6144
    s_nop 0
    buffer_load_dwordx4 v180, s[52:55], s85 offen lds
    s_add_u32 s85, s30, 57344
    s_add_u32 m0, s31, 7168
    s_nop 0
    buffer_load_dwordx4 v180, s[52:55], s85 offen lds
    v_pk_mul_f32 v[64:65], v[38:39], v[54:55]
    v_pk_mul_f32 v[66:67], v[40:41], v[54:55]
    v_pk_mul_f32 v[68:69], v[42:43], v[54:55]
    v_pk_mul_f32 v[70:71], v[44:45], v[54:55]
    v_pk_mul_f32 v[72:73], v[46:47], v[54:55]
    v_pk_mul_f32 v[74:75], v[48:49], v[54:55]
    v_pk_mul_f32 v[76:77], v[50:51], v[54:55]
    v_pk_mul_f32 v[78:79], v[52:53], v[54:55]
    s_add_u32 s85, s30, 65536
    s_add_u32 m0, s31, 8192
    s_nop 0
    buffer_load_dwordx4 v180, s[52:55], s85 offen lds
    s_add_u32 s85, s30, 73728
    s_add_u32 m0, s31, 9216
    s_nop 0
    buffer_load_dwordx4 v180, s[52:55], s85 offen lds
    v_pk_fma_f32 v[64:65], v[36:37], v[56:57], v[64:65]
    v_pk_fma_f32 v[66:67], v[38:39], v[56:57], v[66:67]
    v_pk_fma_f32 v[68:69], v[40:41], v[56:57], v[68:69]
    v_pk_fma_f32 v[70:71], v[42:43], v[56:57], v[70:71]
    v_pk_fma_f32 v[72:73], v[44:45], v[56:57], v[72:73]
    v_pk_fma_f32 v[74:75], v[46:47], v[56:57], v[74:75]
    v_pk_fma_f32 v[76:77], v[48:49], v[56:57], v[76:77]
    v_pk_fma_f32 v[78:79], v[50:51], v[56:57], v[78:79]
    s_add_u32 s85, s30, 81920
    s_add_u32 m0, s31, 10240
    s_nop 0
    buffer_load_dwordx4 v180, s[52:55], s85 offen lds
    s_add_u32 s85, s30, 90112
    s_add_u32 m0, s31, 11264
    s_nop 0
    buffer_load_dwordx4 v180, s[52:55], s85 offen lds
    v_pk_fma_f32 v[64:65], v[34:35], v[58:59], v[64:65]
    v_pk_fma_f32 v[66:67], v[36:37], v[58:59], v[66:67]
    v_pk_fma_f32 v[68:69], v[38:39], v[58:59], v[68:69]
    v_pk_fma_f32 v[70:71], v[40:41], v[58:59], v[70:71]
    v_pk_fma_f32 v[72:73], v[42:43], v[58:59], v[72:73]
    v_pk_fma_f32 v[74:75], v[44:45], v[58:59], v[74:75]
    v_pk_fma_f32 v[76:77], v[46:47], v[58:59], v[76:77]
    v_pk_fma_f32 v[78:79], v[48:49], v[58:59], v[78:79]
    s_add_u32 s85, s30, 98304
    s_add_u32 m0, s31, 12288
    s_nop 0
    buffer_load_dwordx4 v180, s[52:55], s85 offen lds
    s_add_u32 s85, s30, 106496
    s_add_u32 m0, s31, 13312
    s_nop 0
    buffer_load_dwordx4 v180, s[52:55], s85 offen lds
    v_pk_fma_f32 v[64:65], v[32:33], v[60:61], v[64:65]
    v_pk_fma_f32 v[66:67], v[34:35], v[60:61], v[66:67]
    v_pk_fma_f32 v[68:69], v[36:37], v[60:61], v[68:69]
    v_pk_fma_f32 v[70:71], v[38:39], v[60:61], v[70:71]
    v_pk_fma_f32 v[72:73], v[40:41], v[60:61], v[72:73]
    v_pk_fma_f32 v[74:75], v[42:43], v[60:61], v[74:75]
    v_pk_fma_f32 v[76:77], v[44:45], v[60:61], v[76:77]
    v_pk_fma_f32 v[78:79], v[46:47], v[60:61], v[78:79]
    s_waitcnt lgkmcnt(7)
    v_lshlrev_b32 v80, 16, v20
    v_and_b32 v81, 0xffff0000, v20
    s_waitcnt lgkmcnt(6)
    v_lshlrev_b32 v82, 16, v21
    v_and_b32 v83, 0xffff0000, v21
    s_waitcnt lgkmcnt(5)
    v_lshlrev_b32 v84, 16, v22
    v_and_b32 v85, 0xffff0000, v22
    s_waitcnt lgkmcnt(4)
    v_lshlrev_b32 v86, 16, v23
    v_and_b32 v87, 0xffff0000, v23
    s_waitcnt lgkmcnt(3)
    v_lshlrev_b32 v88, 16, v24
    v_and_b32 v89, 0xffff0000, v24
    s_waitcnt lgkmcnt(2)
    v_lshlrev_b32 v90, 16, v25
    v_and_b32 v91, 0xffff0000, v25
    s_waitcnt lgkmcnt(1)
    v_lshlrev_b32 v92, 16, v26
    v_and_b32 v93, 0xffff0000, v26
    s_waitcnt lgkmcnt(0)
    v_lshlrev_b32 v94, 16, v27
    v_and_b32 v95, 0xffff0000, v27
    v_pk_mul_f32 v[64:65], v[64:65], v[80:81]
    v_pk_mul_f32 v[66:67], v[66:67], v[82:83]
    v_pk_mul_f32 v[68:69], v[68:69], v[84:85]
    v_pk_mul_f32 v[70:71], v[70:71], v[86:87]
    v_pk_mul_f32 v[72:73], v[72:73], v[88:89]
    v_pk_mul_f32 v[74:75], v[74:75], v[90:91]
    v_pk_mul_f32 v[76:77], v[76:77], v[92:93]
    v_pk_mul_f32 v[78:79], v[78:79], v[94:95]
    v_cvt_pk_bf16_f32 v96, v64, v65
    v_cvt_pk_bf16_f32 v97, v66, v67
    v_cvt_pk_bf16_f32 v98, v68, v69
    v_cvt_pk_bf16_f32 v99, v70, v71
    v_cvt_pk_bf16_f32 v100, v72, v73
    v_cvt_pk_bf16_f32 v101, v74, v75
    v_cvt_pk_bf16_f32 v102, v76, v77
    v_cvt_pk_bf16_f32 v103, v78, v79
    ds_write_b32 v104, v96 offset:0
    ds_write_b32 v104, v97 offset:128
    ds_write_b32 v105, v98 offset:256
    ds_write_b32 v105, v99 offset:384
    ds_write_b32 v106, v100 offset:512
    ds_write_b32 v106, v101 offset:640
    ds_write_b32 v107, v102 offset:768
    ds_write_b32 v107, v103 offset:896
    s_waitcnt vmcnt(14)
    v_mov_b32 v232, 0
    v_mov_b32 v233, 0
    v_mov_b32 v234, 0
    v_mov_b32 v235, 0
    v_dot2c_f32_bf16 v232, 0x3f803f80, v224
    v_dot2c_f32_bf16 v233, v224, v224
    v_dot2c_f32_bf16 v234, 0x3f803f80, v228
    v_dot2c_f32_bf16 v235, v228, v228
    v_dot2c_f32_bf16 v232, 0x3f803f80, v225
    v_dot2c_f32_bf16 v233, v225, v225
    v_dot2c_f32_bf16 v234, 0x3f803f80, v229
    v_dot2c_f32_bf16 v235, v229, v229
    v_dot2c_f32_bf16 v232, 0x3f803f80, v226
    v_dot2c_f32_bf16 v233, v226, v226
    v_dot2c_f32_bf16 v234, 0x3f803f80, v230
    v_dot2c_f32_bf16 v235, v230, v230
    v_dot2c_f32_bf16 v232, 0x3f803f80, v227
    v_dot2c_f32_bf16 v233, v227, v227
    v_dot2c_f32_bf16 v234, 0x3f803f80, v231
    v_dot2c_f32_bf16 v235, v231, v231
    s_waitcnt lgkmcnt(0)
    s_barrier
    ds_read_b64_tr_b16 v[112:113], v108 offset:4096
    ds_read_b64_tr_b16 v[114:115], v109 offset:4096
    ds_read_b64_tr_b16 v[116:117], v108 offset:0
    ds_read_b64_tr_b16 v[118:119], v109 offset:0
    v_add_f32_dpp v232, v232, v232 row_shr:1 row_mask:0xf bank_mask:0xf
    v_add_f32_dpp v233, v233, v233 row_shr:1 row_mask:0xf bank_mask:0xf
    v_add_f32_dpp v234, v234, v234 row_shr:1 row_mask:0xf bank_mask:0xf
    v_add_f32_dpp v235, v235, v235 row_shr:1 row_mask:0xf bank_mask:0xf
    v_add_f32_dpp v232, v232, v232 row_shr:2 row_mask:0xf bank_mask:0xf
    v_add_f32_dpp v233, v233, v233 row_shr:2 row_mask:0xf bank_mask:0xf
    v_add_f32_dpp v234, v234, v234 row_shr:2 row_mask:0xf bank_mask:0xf
    v_add_f32_dpp v235, v235, v235 row_shr:2 row_mask:0xf bank_mask:0xf
    v_add_f32_dpp v232, v232, v232 row_shr:4 row_mask:0xf bank_mask:0xf
    v_add_f32_dpp v233, v233, v233 row_shr:4 row_mask:0xf bank_mask:0xf
    v_add_f32_dpp v234, v234, v234 row_shr:4 row_mask:0xf bank_mask:0xf
    v_add_f32_dpp v235, v235, v235 row_shr:4 row_mask:0xf bank_mask:0xf
    v_add_f32_dpp v232, v232, v232 row_shr:8 row_mask:0xf bank_mask:0xf
    v_add_f32_dpp v233, v233, v233 row_shr:8 row_mask:0xf bank_mask:0xf
    v_add_f32_dpp v234, v234, v234 row_shr:8 row_mask:0xf bank_mask:0xf
    v_add_f32_dpp v235, v235, v235 row_shr:8 row_mask:0xf bank_mask:0xf
    s_lshl_b32 s80, s73, 18
    s_lshl_b32 s81, s3, 16
    s_add_u32 s80, s80, s81
    s_lshl_b32 s81, s72, 7
    s_sub_u32 s80, s80, s81
    s_add_u32 s80, s80, 1052544
    s_waitcnt lgkmcnt(2)
    buffer_store_dwordx4 v[112:115], v110, s[56:59], s80 offen offset:0 sc1
    s_waitcnt lgkmcnt(0)
    buffer_store_dwordx4 v[116:119], v110, s[56:59], s80 offen offset:64 sc1
    v_add_f32_dpp v232, v232, v232 row_bcast:15 row_mask:0xa bank_mask:0xf
    v_add_f32_dpp v233, v233, v233 row_bcast:15 row_mask:0xa bank_mask:0xf
    v_add_f32_dpp v234, v234, v234 row_bcast:15 row_mask:0xa bank_mask:0xf
    v_add_f32_dpp v235, v235, v235 row_bcast:15 row_mask:0xa bank_mask:0xf
    v_add_f32_dpp v232, v232, v232 row_bcast:31 row_mask:0xc bank_mask:0xf
    v_add_f32_dpp v233, v233, v233 row_bcast:31 row_mask:0xc bank_mask:0xf
    v_add_f32_dpp v234, v234, v234 row_bcast:31 row_mask:0xc bank_mask:0xf
    v_add_f32_dpp v235, v235, v235 row_bcast:31 row_mask:0xc bank_mask:0xf
    s_mov_b32 s100, 0x3b000000
    v_mul_f32 v232, s100, v232
    v_mul_f32 v233, s100, v233
    v_mul_f32 v234, s100, v234
    v_mul_f32 v235, s100, v235
    v_fma_f32 v233, -v232, v232, v233
    v_fma_f32 v235, -v234, v234, v235
    v_max_f32 v233, 0, v233
    v_max_f32 v235, 0, v235
    v_add_f32 v233, 0x3727c5ac, v233
    v_add_f32 v235, 0x3727c5ac, v235
    v_rsq_f32 v233, v233
    v_rsq_f32 v235, v235
    s_lshl_b32 s80, s2, 6
    s_lshl_b32 s81, s3, 4
    s_add_u32 s80, s80, s81
    s_add_u32 s80, s80, 131072
    v_mov_b32 v236, 0
    s_mov_b64 s[92:93], exec
    s_lshl_b64 exec, 1, 63
    buffer_store_dwordx2 v[232:233], v236, s[56:59], s80 offen sc1
    buffer_store_dwordx2 v[234:235], v236, s[56:59], s80 offen offset:8 sc1
    s_mov_b64 exec, s[92:93]
    s_cmp_lg_u32 s3, 0
    s_cbranch_scc1 L_w0_12
    v_mov_b32 v251, 0
    buffer_load_dwordx2 v[248:249], v251, s[64:67], 0 offen sc1
L_w0_12:
    v_lshrrev_b32 v12, 5, v1
    v_bfe_u32 v13, v1, 2, 2
    v_lshl_add_u32 v12, v12, 2, v13
    v_lshlrev_b32 v12, 7, v12
    v_bfe_u32 v13, v1, 3, 1
    v_lshl_or_b32 v12, v13, 6, v12
    v_bfe_u32 v13, v1, 4, 1
    v_lshl_or_b32 v12, v13, 5, v12
    v_and_b32 v13, 3, v1
    v_lshl_or_b32 v12, v13, 3, v12
    v_add_u32 v14, s31, v12
    v_xor_b32 v15, 64, v14
    v_lshlrev_b32 v16, 4, v1
    s_mul_i32 s80, s94, 57344
    s_mul_i32 s81, s3, 14336
    s_add_u32 s80, s80, s81
    s_add_u32 s30, s80, 12582912
    s_waitcnt vmcnt(16)
    ds_read_b64_tr_b16 v[64:65], v14 offset:0
    ds_read_b64_tr_b16 v[66:67], v14 offset:1024
    ds_read_b64_tr_b16 v[68:69], v15 offset:0
    ds_read_b64_tr_b16 v[70:71], v15 offset:1024
    s_waitcnt vmcnt(14)
    ds_read_b64_tr_b16 v[72:73], v14 offset:2048
    ds_read_b64_tr_b16 v[74:75], v14 offset:3072
    ds_read_b64_tr_b16 v[76:77], v15 offset:2048
    ds_read_b64_tr_b16 v[78:79], v15 offset:3072
    s_waitcnt vmcnt(12)
    ds_read_b64_tr_b16 v[80:81], v14 offset:4096
    ds_read_b64_tr_b16 v[82:83], v14 offset:5120
    ds_read_b64_tr_b16 v[84:85], v15 offset:4096
    ds_read_b64_tr_b16 v[86:87], v15 offset:5120
    s_waitcnt vmcnt(10)
    ds_read_b64_tr_b16 v[88:89], v14 offset:6144
    ds_read_b64_tr_b16 v[90:91], v14 offset:7168
    ds_read_b64_tr_b16 v[92:93], v15 offset:6144
    ds_read_b64_tr_b16 v[94:95], v15 offset:7168
    s_waitcnt vmcnt(8)
    ds_read_b64_tr_b16 v[96:97], v14 offset:8192
    ds_read_b64_tr_b16 v[98:99], v14 offset:9216
    ds_read_b64_tr_b16 v[100:101], v15 offset:8192
    ds_read_b64_tr_b16 v[102:103], v15 offset:9216
    s_waitcnt vmcnt(6)
    ds_read_b64_tr_b16 v[104:105], v14 offset:10240
    ds_read_b64_tr_b16 v[106:107], v14 offset:11264
    ds_read_b64_tr_b16 v[108:109], v15 offset:10240
    ds_read_b64_tr_b16 v[110:111], v15 offset:11264
    s_waitcnt vmcnt(4)
    ds_read_b64_tr_b16 v[112:113], v14 offset:12288
    ds_read_b64_tr_b16 v[114:115], v14 offset:13312
    ds_read_b64_tr_b16 v[116:117], v15 offset:12288
    ds_read_b64_tr_b16 v[118:119], v15 offset:13312
    s_waitcnt lgkmcnt(15)
    buffer_store_dwordx4 v[64:67], v16, s[56:59], s30 offen offset:0 sc1
    buffer_store_dwordx4 v[68:71], v16, s[56:59], s30 offen offset:1024 sc1
    s_waitcnt lgkmcnt(15)
    s_add_u32 s30, s30, 2048
    buffer_store_dwordx4 v[72:75], v16, s[56:59], s30 offen offset:0 sc1
    buffer_store_dwordx4 v[76:79], v16, s[56:59], s30 offen offset:1024 sc1
    s_waitcnt lgkmcnt(15)
    s_add_u32 s30, s30, 2048
    buffer_store_dwordx4 v[80:83], v16, s[56:59], s30 offen offset:0 sc1
    buffer_store_dwordx4 v[84:87], v16, s[56:59], s30 offen offset:1024 sc1
    s_waitcnt lgkmcnt(12)
    s_add_u32 s30, s30, 2048
    buffer_store_dwordx4 v[88:91], v16, s[56:59], s30 offen offset:0 sc1
    buffer_store_dwordx4 v[92:95], v16, s[56:59], s30 offen offset:1024 sc1
    s_waitcnt lgkmcnt(8)
    s_add_u32 s30, s30, 2048
    buffer_store_dwordx4 v[96:99], v16, s[56:59], s30 offen offset:0 sc1
    buffer_store_dwordx4 v[100:103], v16, s[56:59], s30 offen offset:1024 sc1
    s_waitcnt lgkmcnt(4)
    s_add_u32 s30, s30, 2048
    buffer_store_dwordx4 v[104:107], v16, s[56:59], s30 offen offset:0 sc1
    buffer_store_dwordx4 v[108:111], v16, s[56:59], s30 offen offset:1024 sc1
    s_waitcnt lgkmcnt(0)
    s_add_u32 s30, s30, 2048
    buffer_store_dwordx4 v[112:115], v16, s[56:59], s30 offen offset:0 sc1
    buffer_store_dwordx4 v[116:119], v16, s[56:59], s30 offen offset:1024 sc1
    s_waitcnt vmcnt(0)
    s_barrier
    s_cmp_lg_u32 s3, 0
    s_cbranch_scc1 L_w0_13
    s_mov_b32 s95, 0
L_nonce_14:
    v_readfirstlane_b32 s90, v248
    v_readfirstlane_b32 s91, v249
    s_add_u32 s95, s95, 1
    s_cmp_ge_u32 s95, 0x40000
    s_cbranch_scc1 L_nonce_done_15
    s_cmp_lg_u32 s90, 0
    s_cbranch_scc1 L_nonce_done_15
    buffer_load_dwordx2 v[248:249], v251, s[64:67], 0 offen sc1
    s_waitcnt vmcnt(0)
    s_branch L_nonce_14
L_nonce_done_15:
    s_lshl_b32 s80, s2, 7
    v_mov_b32 v247, s80
    v_mov_b32 v244, s90
    v_mov_b32 v245, s91
    s_mov_b64 s[92:93], exec
    s_mov_b64 exec, 1
    buffer_store_dwordx2 v[244:245], v247, s[56:59], 0 offen sc1
    s_mov_b64 exec, s[92:93]
L_w0_13:
    s_cmp_lg_u32 s3, 0
    s_cbranch_scc1 L_w0_16
    s_lshl_b32 s80, s94, 7
    s_add_u32 s80, s80, 98304
    v_mov_b32 v247, s80
    v_mov_b32 v244, s90
    v_mov_b32 v245, s91
    s_mov_b64 s[92:93], exec
    s_mov_b64 exec, 1
    buffer_store_dwordx2 v[244:245], v247, s[56:59], 0 offen sc1
    s_mov_b64 exec, s[92:93]
L_w0_16:
    s_mul_i32 s84, s86, 8960
    s_mul_i32 s85, s87, 4368
    s_add_u32 s101, s84, s85
    s_lshl_b32 s84, s87, 1
    s_sub_u32 s84, s84, 250
    v_lshl_add_u32 v200, v1, 4, s84
    s_add_u32 m0, s101, 0
    s_nop 0
    buffer_load_dwordx4 v200, s[44:47], 0 offen lds
    v_add_u32 v200, 1024, v200
    s_add_u32 m0, s101, 1024
    s_nop 0
    buffer_load_dwordx4 v200, s[44:47], 0 offen lds
    v_add_u32 v200, 1024, v200
    s_add_u32 m0, s101, 2048
    s_nop 0
    buffer_load_dwordx4 v200, s[44:47], 0 offen lds
    v_add_u32 v200, 1024, v200
    s_add_u32 m0, s101, 3072
    s_nop 0
    buffer_load_dwordx4 v200, s[44:47], 0 offen lds
    v_add_u32 v200, 1024, v200
    s_mov_b64 s[92:93], exec
    s_mov_b64 exec, 0xffff
    s_add_u32 m0, s101, 4096
    s_nop 0
    buffer_load_dwordx4 v200, s[44:47], 0 offen lds
    s_mov_b64 exec, s[92:93]
    v_and_b32 v10, 7, v1
    v_lshrrev_b32 v11, 4, v1
    v_xor_b32 v10, v10, v11
    v_lshrrev_b32 v11, 3, v1
    v_lshlrev_b32 v11, 10, v11
    v_lshl_or_b32 v10, v10, 4, v11
    v_xor_b32 v11, 64, v10
    s_lshl_b32 s80, s72, 16
    s_lshl_b32 s81, s73, 7
    s_add_u32 s80, s80, s81
    s_lshl_b32 s81, s3, 14
    s_add_u32 s80, s80, s81
    s_lshl_b32 s83, s3, 11
    s_add_u32 m0, s83, 139264
    s_nop 0
    buffer_load_dwordx4 v10, s[32:35], s80 offen lds
    s_add_u32 s80, s80, 8192
    s_add_u32 m0, s83, 140288
    s_nop 0
    buffer_load_dwordx4 v11, s[32:35], s80 offen lds
    s_cmp_lg_u32 s3, 0
    s_cbranch_scc1 L_w0_17
    v_and_b32 v250, 31, v1
    s_and_b32 s82, s2, 0xe0
    v_add_u32 v250, s82, v250
    v_lshlrev_b32 v250, 7, v250
    v_and_b32 v251, 3, v1
    s_lshl_b32 s82, s73, 2
    v_add_u32 v251, s82, v251
    v_lshlrev_b32 v251, 7, v251
    v_add_u32 v251, 98304, v251
    v_cmp_lt_u32 vcc, 31, v1
    s_nop 1
    v_cndmask_b32 v250, v250, v251, vcc
    buffer_load_dwordx2 v[252:253], v250, s[56:59], 0 offen sc1
L_w0_17:
    s_cmp_lg_u32 s3, 0
    s_cbranch_scc1 L_w0_18
    s_waitcnt vmcnt(0)
    s_mov_b32 s95, 0
L_poll_19:
    v_cmp_ne_u32 vcc, s90, v252
    v_cmp_ne_u32 s[92:93], s91, v253
    s_nop 1
    s_or_b64 vcc, vcc, s[92:93]
    s_cmp_eq_u64 vcc, 0
    s_cbranch_scc1 L_poll_done_20
    s_add_u32 s95, s95, 1
    s_cmp_ge_u32 s95, 0x40000
    s_cbranch_scc1 L_poll_done_20
    buffer_load_dwordx2 v[252:253], v250, s[56:59], 0 offen sc1
    s_waitcnt vmcnt(0)
    s_branch L_poll_19
L_poll_done_20:
L_w0_18:
    s_barrier
    s_lshl_b32 s80, s89, 12
    s_add_u32 s80, s80, 1048576
    s_add_u32 s68, s28, s80
    s_addc_u32 s69, s29, 0
    s_mov_b32 s70, 4096
    s_mov_b32 s71, 0x00020000
    s_lshl_b32 s81, s87, 2
    s_sub_u32 s81, 4, s81
    v_lshl_add_u32 v208, v1, 4, s81
    buffer_load_dwordx4 v[212:215], v208, s[68:71], 0 offen offset:0 sc1
    buffer_load_dwordx4 v[216:219], v208, s[68:71], 0 offen offset:1024 sc1
    buffer_load_dwordx4 v[220:223], v208, s[68:71], 0 offen offset:2048 sc1
    buffer_load_dwordx4 v[224:227], v208, s[68:71], 0 offen offset:3072 sc1
    s_mul_i32 s80, s86, 13056
    s_mul_i32 s81, s87, 6528
    s_add_u32 s80, s80, s81
    s_add_u32 s80, s80, 18432
    v_lshrrev_b32 v209, 4, v1
    v_add_u32 v209, v209, v1
    v_lshl_add_u32 v209, v209, 4, s80
    v_lshl_add_u32 v210, v1, 4, s80
    v_mov_b32 v228, 0
    v_mov_b32 v229, 0
    v_mov_b32 v230, 0
    v_mov_b32 v231, 0
    ds_write_b128 v210, v[228:231] offset:4352
    ds_write_b128 v210, v[228:231] offset:5376
    s_waitcnt vmcnt(3)
    ds_write_b128 v209, v[212:215] offset:0
    s_waitcnt vmcnt(2)
    ds_write_b128 v209, v[216:219] offset:1088
    s_waitcnt vmcnt(1)
    ds_write_b128 v209, v[220:223] offset:2176
    s_waitcnt vmcnt(0)
    ds_write_b128 v209, v[224:227] offset:3264
    s_lshl_b32 s80, s73, 2
    s_add_u32 s80, s80, s3
    s_mul_i32 s80, s80, 57344
    s_add_u32 s80, s80, 12582912
    s_lshl_b32 s81, s86, 10
    s_add_u32 s16, s80, s81
    s_xor_b32 s81, s81, 1024
    s_add_u32 s17, s80, s81
    v_lshlrev_b32 v235, 4, v1
    buffer_load_dwordx4 a[0:3], v235, s[56:59], s16 offen offset:0 sc1
    buffer_load_dwordx4 a[4:7], v235, s[56:59], s17 offen offset:0 sc1
    buffer_load_dwordx4 a[8:11], v235, s[56:59], s16 offen offset:2048 sc1
    buffer_load_dwordx4 a[12:15], v235, s[56:59], s17 offen offset:2048 sc1
    s_add_u32 s16, s16, 4096
    buffer_load_dwordx4 a[16:19], v235, s[56:59], s16 offen offset:0 sc1
    s_add_u32 s17, s17, 4096
    buffer_load_dwordx4 a[20:23], v235, s[56:59], s17 offen offset:0 sc1
    buffer_load_dwordx4 a[24:27], v235, s[56:59], s16 offen offset:2048 sc1
    buffer_load_dwordx4 a[28:31], v235, s[56:59], s17 offen offset:2048 sc1
    s_add_u32 s16, s16, 4096
    buffer_load_dwordx4 a[32:35], v235, s[56:59], s16 offen offset:0 sc1
    s_add_u32 s17, s17, 4096
    buffer_load_dwordx4 a[36:39], v235, s[56:59], s17 offen offset:0 sc1
    buffer_load_dwordx4 a[40:43], v235, s[56:59], s16 offen offset:2048 sc1
    buffer_load_dwordx4 a[44:47], v235, s[56:59], s17 offen offset:2048 sc1
    s_add_u32 s16, s16, 4096
    buffer_load_dwordx4 a[48:51], v235, s[56:59], s16 offen offset:0 sc1
    s_add_u32 s17, s17, 4096
    buffer_load_dwordx4 a[52:55], v235, s[56:59], s17 offen offset:0 sc1
    buffer_load_dwordx4 a[56:59], v235, s[56:59], s16 offen offset:2048 sc1
    buffer_load_dwordx4 a[60:63], v235, s[56:59], s17 offen offset:2048 sc1
    s_add_u32 s16, s16, 4096
    buffer_load_dwordx4 a[64:67], v235, s[56:59], s16 offen offset:0 sc1
    s_add_u32 s17, s17, 4096
    buffer_load_dwordx4 a[68:71], v235, s[56:59], s17 offen offset:0 sc1
    buffer_load_dwordx4 a[72:75], v235, s[56:59], s16 offen offset:2048 sc1
    buffer_load_dwordx4 a[76:79], v235, s[56:59], s17 offen offset:2048 sc1
    s_add_u32 s16, s16, 4096
    buffer_load_dwordx4 a[80:83], v235, s[56:59], s16 offen offset:0 sc1
    s_add_u32 s17, s17, 4096
    buffer_load_dwordx4 a[84:87], v235, s[56:59], s17 offen offset:0 sc1
    buffer_load_dwordx4 a[88:91], v235, s[56:59], s16 offen offset:2048 sc1
    buffer_load_dwordx4 a[92:95], v235, s[56:59], s17 offen offset:2048 sc1
    s_add_u32 s16, s16, 4096
    buffer_load_dwordx4 a[96:99], v235, s[56:59], s16 offen offset:0 sc1
    s_add_u32 s17, s17, 4096
    buffer_load_dwordx4 a[100:103], v235, s[56:59], s17 offen offset:0 sc1
    buffer_load_dwordx4 a[104:107], v235, s[56:59], s16 offen offset:2048 sc1
    buffer_load_dwordx4 a[108:111], v235, s[56:59], s17 offen offset:2048 sc1
    s_add_u32 s16, s16, 4096
    buffer_load_dwordx4 a[112:115], v235, s[56:59], s16 offen offset:0 sc1
    s_add_u32 s17, s17, 4096
    buffer_load_dwordx4 a[116:119], v235, s[56:59], s17 offen offset:0 sc1
    buffer_load_dwordx4 a[120:123], v235, s[56:59], s16 offen offset:2048 sc1
    buffer_load_dwordx4 a[124:127], v235, s[56:59], s17 offen offset:2048 sc1
    s_add_u32 s16, s16, 4096
    buffer_load_dwordx4 a[128:131], v235, s[56:59], s16 offen offset:0 sc1
    s_add_u32 s17, s17, 4096
    buffer_load_dwordx4 a[132:135], v235, s[56:59], s17 offen offset:0 sc1
    s_lshl_b32 s84, s4, 16
    s_lshr_b32 s85, s4, 16
    s_lshl_b32 s80, s5, 16
    s_or_b32 s85, s85, s80
    s_cmp_eq_u32 s87, 0
    s_cselect_b32 s84, s84, s4
    s_cselect_b32 s85, s85, s5
    v_mov_b32 v204, 0
    v_mov_b32 v205, 0
    v_mov_b32 v206, s84
    v_mov_b32 v207, s85
    s_mul_i32 s84, s86, 8960
    s_mul_i32 s85, s87, 4368
    s_add_u32 s84, s84, s85
    s_add_u32 s84, s84, 240
    v_mov_b32 v203, s84
    s_mov_b64 s[92:93], exec
    s_mov_b64 exec, 1
    ds_write_b128 v203, v[204:207]
    s_mov_b64 exec, s[92:93]
    s_waitcnt vmcnt(0)
L_join:
    s_nop 4
    v_and_b32 v202, 1, v1
    v_mul_u32_u24 v202, 4368, v202
    v_bfe_u32 v203, v1, 1, 3
    v_lshl_add_u32 v202, v203, 5, v202
    v_lshrrev_b32 v204, 4, v1
    v_lshl_add_u32 v202, v204, 9, v202
    s_mul_i32 s80, s86, 8960
    s_add_u32 s80, s80, 0
    v_add_u32 v200, s80, v202
    v_and_b32 v202, 1, v1
    v_mul_u32_u24 v202, 6528, v202
    v_lshlrev_b32 v204, 1, v204
    v_sub_u32 v204, v204, v203
    v_add_u32 v204, 7, v204
    v_mul_u32_u24 v204, 272, v204
    v_add_u32 v202, v202, v204
    s_mul_i32 s80, s86, 13056
    s_add_u32 s80, s80, 18432
    v_add_u32 v201, s80, v202
    s_waitcnt lgkmcnt(0)
    s_barrier
    s_cmp_eq_u32 s87, 0
    s_cbranch_scc0 L_cvB_21
    ds_read_b128 v[64:67], v200 offset:0
    ds_read_b128 v[68:71], v200 offset:16
    ds_read_b128 v[72:75], v200 offset:32
    ds_read_b128 v[40:43], v201 offset:2176
    ds_read_b128 v[44:47], v201 offset:0
    ds_read_b128 v[76:79], v200 offset:48
    ds_read_b128 v[48:51], v201 offset:2192
    ds_read_b128 v[52:55], v201 offset:16
    s_waitcnt lgkmcnt(4)
    v_mfma_f32_16x16x32_bf16 v[8:11], v[64:67], v[40:43], 0
    ds_read_b128 v[80:83], v200 offset:64
    v_mfma_f32_16x16x32_bf16 v[12:15], v[66:69], v[40:43], 0
    ds_read_b128 v[56:59], v201 offset:2208
    ds_read_b128 v[60:63], v201 offset:32
    v_mfma_f32_16x16x32_bf16 v[16:19], v[68:71], v[40:43], 0
    buffer_load_dwordx4 a[136:139], v235, s[56:59], s16 offen offset:2048 sc1
    v_mfma_f32_16x16x32_bf16 v[20:23], v[70:73], v[40:43], 0
    s_waitcnt lgkmcnt(6)
    v_mfma_f32_16x16x32_bf16 v[24:27], v[64:67], v[44:47], 0
    v_mfma_f32_16x16x32_bf16 v[28:31], v[66:69], v[44:47], 0
    v_mfma_f32_16x16x32_bf16 v[32:35], v[68:71], v[44:47], 0
    buffer_load_dwordx4 a[140:143], v235, s[56:59], s17 offen offset:2048 sc1
    v_mfma_f32_16x16x32_bf16 v[36:39], v[70:73], v[44:47], 0
    s_waitcnt lgkmcnt(4)
    v_mfma_f32_16x16x32_bf16 v[8:11], v[68:71], v[48:51], v[8:11]
    ds_read_b128 v[84:87], v200 offset:80
    v_mfma_f32_16x16x32_bf16 v[12:15], v[70:73], v[48:51], v[12:15]
    ds_read_b128 v[40:43], v201 offset:2224
    ds_read_b128 v[44:47], v201 offset:48
    v_mfma_f32_16x16x32_bf16 v[16:19], v[72:75], v[48:51], v[16:19]
    s_add_u32 s16, s16, 4096
    buffer_load_dwordx4 a[144:147], v235, s[56:59], s16 offen offset:0 sc1
    v_mfma_f32_16x16x32_bf16 v[20:23], v[74:77], v[48:51], v[20:23]
    s_waitcnt lgkmcnt(6)
    v_mfma_f32_16x16x32_bf16 v[24:27], v[68:71], v[52:55], v[24:27]
    v_mfma_f32_16x16x32_bf16 v[28:31], v[70:73], v[52:55], v[28:31]
    v_mfma_f32_16x16x32_bf16 v[32:35], v[72:75], v[52:55], v[32:35]
    s_add_u32 s17, s17, 4096
    buffer_load_dwordx4 a[148:151], v235, s[56:59], s17 offen offset:0 sc1
    v_mfma_f32_16x16x32_bf16 v[36:39], v[74:77], v[52:55], v[36:39]
    s_waitcnt lgkmcnt(4)
    v_mfma_f32_16x16x32_bf16 v[8:11], v[72:75], v[56:59], v[8:11]
    ds_read_b128 v[88:91], v200 offset:96
    v_mfma_f32_16x16x32_bf16 v[12:15], v[74:77], v[56:59], v[12:15]
    ds_read_b128 v[48:51], v201 offset:2240
    ds_read_b128 v[52:55], v201 offset:64
    v_mfma_f32_16x16x32_bf16 v[16:19], v[76:79], v[56:59], v[16:19]
    buffer_load_dwordx4 a[152:155], v235, s[56:59], s16 offen offset:2048 sc1
    v_mfma_f32_16x16x32_bf16 v[20:23], v[78:81], v[56:59], v[20:23]
    s_waitcnt lgkmcnt(6)
    v_mfma_f32_16x16x32_bf16 v[24:27], v[72:75], v[60:63], v[24:27]
    v_mfma_f32_16x16x32_bf16 v[28:31], v[74:77], v[60:63], v[28:31]
    v_mfma_f32_16x16x32_bf16 v[32:35], v[76:79], v[60:63], v[32:35]
    buffer_load_dwordx4 a[156:159], v235, s[56:59], s17 offen offset:2048 sc1
    v_mfma_f32_16x16x32_bf16 v[36:39], v[78:81], v[60:63], v[36:39]
    s_waitcnt lgkmcnt(4)
    v_mfma_f32_16x16x32_bf16 v[8:11], v[76:79], v[40:43], v[8:11]
    ds_read_b128 v[92:95], v200 offset:112
    v_mfma_f32_16x16x32_bf16 v[12:15], v[78:81], v[40:43], v[12:15]
    ds_read_b128 v[56:59], v201 offset:2256
    ds_read_b128 v[60:63], v201 offset:80
    v_mfma_f32_16x16x32_bf16 v[16:19], v[80:83], v[40:43], v[16:19]
    s_add_u32 s16, s16, 4096
    buffer_load_dwordx4 a[160:163], v235, s[56:59], s16 offen offset:0 sc1
    v_mfma_f32_16x16x32_bf16 v[20:23], v[82:85], v[40:43], v[20:23]
    s_waitcnt lgkmcnt(6)
    v_mfma_f32_16x16x32_bf16 v[24:27], v[76:79], v[44:47], v[24:27]
    v_mfma_f32_16x16x32_bf16 v[28:31], v[78:81], v[44:47], v[28:31]
    v_mfma_f32_16x16x32_bf16 v[32:35], v[80:83], v[44:47], v[32:35]
    s_add_u32 s17, s17, 4096
    buffer_load_dwordx4 a[164:167], v235, s[56:59], s17 offen offset:0 sc1
    v_mfma_f32_16x16x32_bf16 v[36:39], v[82:85], v[44:47], v[36:39]
    s_waitcnt lgkmcnt(4)
    v_mfma_f32_16x16x32_bf16 v[8:11], v[80:83], v[48:51], v[8:11]
    ds_read_b128 v[96:99], v200 offset:128
    v_mfma_f32_16x16x32_bf16 v[12:15], v[82:85], v[48:51], v[12:15]
    ds_read_b128 v[40:43], v201 offset:2272
    ds_read_b128 v[44:47], v201 offset:96
    v_mfma_f32_16x16x32_bf16 v[16:19], v[84:87], v[48:51], v[16:19]
    buffer_load_dwordx4 a[168:171], v235, s[56:59], s16 offen offset:2048 sc1
    v_mfma_f32_16x16x32_bf16 v[20:23], v[86:89], v[48:51], v[20:23]
    s_waitcnt lgkmcnt(6)
    v_mfma_f32_16x16x32_bf16 v[24:27], v[80:83], v[52:55], v[24:27]
    v_mfma_f32_16x16x32_bf16 v[28:31], v[82:85], v[52:55], v[28:31]
    v_mfma_f32_16x16x32_bf16 v[32:35], v[84:87], v[52:55], v[32:35]
    buffer_load_dwordx4 a[172:175], v235, s[56:59], s17 offen offset:2048 sc1
    v_mfma_f32_16x16x32_bf16 v[36:39], v[86:89], v[52:55], v[36:39]
    s_waitcnt lgkmcnt(4)
    v_mfma_f32_16x16x32_bf16 v[8:11], v[84:87], v[56:59], v[8:11]
    ds_read_b128 v[100:103], v200 offset:144
    v_mfma_f32_16x16x32_bf16 v[12:15], v[86:89], v[56:59], v[12:15]
    ds_read_b128 v[48:51], v201 offset:2288
    ds_read_b128 v[52:55], v201 offset:112
    v_mfma_f32_16x16x32_bf16 v[16:19], v[88:91], v[56:59], v[16:19]
    s_add_u32 s16, s16, 4096
    buffer_load_dwordx4 a[176:179], v235, s[56:59], s16 offen offset:0 sc1
    v_mfma_f32_16x16x32_bf16 v[20:23], v[90:93], v[56:59], v[20:23]
    s_waitcnt lgkmcnt(6)
    v_mfma_f32_16x16x32_bf16 v[24:27], v[84:87], v[60:63], v[24:27]
    v_mfma_f32_16x16x32_bf16 v[28:31], v[86:89], v[60:63], v[28:31]
    v_mfma_f32_16x16x32_bf16 v[32:35], v[88:91], v[60:63], v[32:35]
    s_add_u32 s17, s17, 4096
    buffer_load_dwordx4 a[180:183], v235, s[56:59], s17 offen offset:0 sc1
    v_mfma_f32_16x16x32_bf16 v[36:39], v[90:93], v[60:63], v[36:39]
    s_waitcnt vmcnt(12)
    s_barrier
    s_cmp_ge_u32 s76, 28
    s_cbranch_scc1 L_nosigB_23
    s_cmp_lg_u32 s3, 0
    s_cbranch_scc1 L_w0_24
    s_lshl_b32 s80, s2, 7
    s_add_u32 s80, s80, 32768
    v_mov_b32 v247, s80
    v_mov_b32 v244, s90
    v_mov_b32 v245, s91
    s_mov_b64 s[92:93], exec
    s_mov_b64 exec, 1
    buffer_store_dwordx2 v[244:245], v247, s[56:59], 0 offen sc1
    s_mov_b64 exec, s[92:93]
L_w0_24:
L_nosigB_23:
    s_waitcnt lgkmcnt(4)
    v_mfma_f32_16x16x32_bf16 v[8:11], v[88:91], v[40:43], v[8:11]
    ds_read_b128 v[104:107], v200 offset:160
    v_mfma_f32_16x16x32_bf16 v[12:15], v[90:93], v[40:43], v[12:15]
    ds_read_b128 v[56:59], v201 offset:2304
    ds_read_b128 v[60:63], v201 offset:128
    v_mfma_f32_16x16x32_bf16 v[16:19], v[92:95], v[40:43], v[16:19]
    buffer_load_dwordx4 a[184:187], v235, s[56:59], s16 offen offset:2048 sc1
    v_mfma_f32_16x16x32_bf16 v[20:23], v[94:97], v[40:43], v[20:23]
    s_waitcnt lgkmcnt(6)
    v_mfma_f32_16x16x32_bf16 v[24:27], v[88:91], v[44:47], v[24:27]
    v_mfma_f32_16x16x32_bf16 v[28:31], v[90:93], v[44:47], v[28:31]
    v_mfma_f32_16x16x32_bf16 v[32:35], v[92:95], v[44:47], v[32:35]
    buffer_load_dwordx4 a[188:191], v235, s[56:59], s17 offen offset:2048 sc1
    v_mfma_f32_16x16x32_bf16 v[36:39], v[94:97], v[44:47], v[36:39]
    s_waitcnt lgkmcnt(4)
    v_mfma_f32_16x16x32_bf16 v[8:11], v[92:95], v[48:51], v[8:11]
    ds_read_b128 v[108:111], v200 offset:176
    v_mfma_f32_16x16x32_bf16 v[12:15], v[94:97], v[48:51], v[12:15]
    ds_read_b128 v[40:43], v201 offset:2320
    ds_read_b128 v[44:47], v201 offset:144
    v_mfma_f32_16x16x32_bf16 v[16:19], v[96:99], v[48:51], v[16:19]
    s_add_u32 s16, s16, 4096
    buffer_load_dwordx4 a[192:195], v235, s[56:59], s16 offen offset:0 sc1
    v_mfma_f32_16x16x32_bf16 v[20:23], v[98:101], v[48:51], v[20:23]
    s_waitcnt lgkmcnt(6)
    v_mfma_f32_16x16x32_bf16 v[24:27], v[92:95], v[52:55], v[24:27]
    v_mfma_f32_16x16x32_bf16 v[28:31], v[94:97], v[52:55], v[28:31]
    v_mfma_f32_16x16x32_bf16 v[32:35], v[96:99], v[52:55], v[32:35]
    s_add_u32 s17, s17, 4096
    buffer_load_dwordx4 a[196:199], v235, s[56:59], s17 offen offset:0 sc1
    v_mfma_f32_16x16x32_bf16 v[36:39], v[98:101], v[52:55], v[36:39]
    s_waitcnt lgkmcnt(4)
    v_mfma_f32_16x16x32_bf16 v[8:11], v[96:99], v[56:59], v[8:11]
    ds_read_b128 v[112:115], v200 offset:192
    v_mfma_f32_16x16x32_bf16 v[12:15], v[98:101], v[56:59], v[12:15]
    ds_read_b128 v[48:51], v201 offset:2336
    ds_read_b128 v[52:55], v201 offset:160
    v_mfma_f32_16x16x32_bf16 v[16:19], v[100:103], v[56:59], v[16:19]
    buffer_load_dwordx4 a[200:203], v235, s[56:59], s16 offen offset:2048 sc1
    v_mfma_f32_16x16x32_bf16 v[20:23], v[102:105], v[56:59], v[20:23]
    s_waitcnt lgkmcnt(6)
    v_mfma_f32_16x16x32_bf16 v[24:27], v[96:99], v[60:63], v[24:27]
    v_mfma_f32_16x16x32_bf16 v[28:31], v[98:101], v[60:63], v[28:31]
    v_mfma_f32_16x16x32_bf16 v[32:35], v[100:103], v[60:63], v[32:35]
    buffer_load_dwordx4 a[204:207], v235, s[56:59], s17 offen offset:2048 sc1
    v_mfma_f32_16x16x32_bf16 v[36:39], v[102:105], v[60:63], v[36:39]
    s_waitcnt lgkmcnt(4)
    v_mfma_f32_16x16x32_bf16 v[8:11], v[100:103], v[40:43], v[8:11]
    ds_read_b128 v[116:119], v200 offset:208
    v_mfma_f32_16x16x32_bf16 v[12:15], v[102:105], v[40:43], v[12:15]
    ds_read_b128 v[56:59], v201 offset:2352
    ds_read_b128 v[60:63], v201 offset:176
    v_mfma_f32_16x16x32_bf16 v[16:19], v[104:107], v[40:43], v[16:19]
    s_add_u32 s16, s16, 4096
    buffer_load_dwordx4 a[208:211], v235, s[56:59], s16 offen offset:0 sc1
    v_mfma_f32_16x16x32_bf16 v[20:23], v[106:109], v[40:43], v[20:23]
    s_waitcnt lgkmcnt(6)
    v_mfma_f32_16x16x32_bf16 v[24:27], v[100:103], v[44:47], v[24:27]
    v_mfma_f32_16x16x32_bf16 v[28:31], v[102:105], v[44:47], v[28:31]
    v_mfma_f32_16x16x32_bf16 v[32:35], v[104:107], v[44:47], v[32:35]
    s_add_u32 s17, s17, 4096
    buffer_load_dwordx4 a[212:215], v235, s[56:59], s17 offen offset:0 sc1
    v_mfma_f32_16x16x32_bf16 v[36:39], v[106:109], v[44:47], v[36:39]
    s_waitcnt lgkmcnt(4)
    v_mfma_f32_16x16x32_bf16 v[8:11], v[104:107], v[48:51], v[8:11]
    ds_read_b128 v[120:123], v200 offset:224
    v_mfma_f32_16x16x32_bf16 v[12:15], v[106:109], v[48:51], v[12:15]
    ds_read_b128 v[40:43], v201 offset:2368
    ds_read_b128 v[44:47], v201 offset:192
    v_mfma_f32_16x16x32_bf16 v[16:19], v[108:111], v[48:51], v[16:19]
    buffer_load_dwordx4 a[216:219], v235, s[56:59], s16 offen offset:2048 sc1
    v_mfma_f32_16x16x32_bf16 v[20:23], v[110:113], v[48:51], v[20:23]
    s_waitcnt lgkmcnt(6)
    v_mfma_f32_16x16x32_bf16 v[24:27], v[104:107], v[52:55], v[24:27]
    v_mfma_f32_16x16x32_bf16 v[28:31], v[106:109], v[52:55], v[28:31]
    v_mfma_f32_16x16x32_bf16 v[32:35], v[108:111], v[52:55], v[32:35]
    buffer_load_dwordx4 a[220:223], v235, s[56:59], s17 offen offset:2048 sc1
    v_mfma_f32_16x16x32_bf16 v[36:39], v[110:113], v[52:55], v[36:39]
    s_waitcnt lgkmcnt(4)
    v_mfma_f32_16x16x32_bf16 v[8:11], v[108:111], v[56:59], v[8:11]
    ds_read_b128 v[124:127], v200 offset:240
    v_mfma_f32_16x16x32_bf16 v[12:15], v[110:113], v[56:59], v[12:15]
    ds_read_b128 v[48:51], v201 offset:2384
    ds_read_b128 v[52:55], v201 offset:208
    v_mfma_f32_16x16x32_bf16 v[16:19], v[112:115], v[56:59], v[16:19]
    v_mfma_f32_16x16x32_bf16 v[20:23], v[114:117], v[56:59], v[20:23]
    s_waitcnt lgkmcnt(6)
    v_mfma_f32_16x16x32_bf16 v[24:27], v[108:111], v[60:63], v[24:27]
    v_mfma_f32_16x16x32_bf16 v[28:31], v[110:113], v[60:63], v[28:31]
    v_mfma_f32_16x16x32_bf16 v[32:35], v[112:115], v[60:63], v[32:35]
    v_mfma_f32_16x16x32_bf16 v[36:39], v[114:117], v[60:63], v[36:39]
    s_waitcnt lgkmcnt(4)
    v_mfma_f32_16x16x32_bf16 v[8:11], v[112:115], v[40:43], v[8:11]
    ds_read_b128 v[64:67], v200 offset:256
    ds_read_b128 v[128:131], v200 offset:256
    v_mfma_f32_16x16x32_bf16 v[12:15], v[114:117], v[40:43], v[12:15]
    ds_read_b128 v[56:59], v201 offset:2400
    ds_read_b128 v[60:63], v201 offset:224
    v_mfma_f32_16x16x32_bf16 v[16:19], v[116:119], v[40:43], v[16:19]
    v_mfma_f32_16x16x32_bf16 v[20:23], v[118:121], v[40:43], v[20:23]
    s_waitcnt lgkmcnt(7)
    v_mfma_f32_16x16x32_bf16 v[24:27], v[112:115], v[44:47], v[24:27]
    v_mfma_f32_16x16x32_bf16 v[28:31], v[114:117], v[44:47], v[28:31]
    v_mfma_f32_16x16x32_bf16 v[32:35], v[116:119], v[44:47], v[32:35]
    v_mfma_f32_16x16x32_bf16 v[36:39], v[118:121], v[44:47], v[36:39]
    s_waitcnt lgkmcnt(5)
    v_mfma_f32_16x16x32_bf16 v[8:11], v[116:119], v[48:51], v[8:11]
    ds_read_b128 v[68:71], v200 offset:272
    ds_read_b128 v[132:135], v200 offset:272
    v_mfma_f32_16x16x32_bf16 v[12:15], v[118:121], v[48:51], v[12:15]
    ds_read_b128 v[40:43], v201 offset:2416
    ds_read_b128 v[44:47], v201 offset:240
    v_mfma_f32_16x16x32_bf16 v[16:19], v[120:123], v[48:51], v[16:19]
    v_mfma_f32_16x16x32_bf16 v[20:23], v[122:125], v[48:51], v[20:23]
    s_waitcnt lgkmcnt(8)
    v_mfma_f32_16x16x32_bf16 v[24:27], v[116:119], v[52:55], v[24:27]
    v_mfma_f32_16x16x32_bf16 v[28:31], v[118:121], v[52:55], v[28:31]
    v_mfma_f32_16x16x32_bf16 v[32:35], v[120:123], v[52:55], v[32:35]
    v_mfma_f32_16x16x32_bf16 v[36:39], v[122:125], v[52:55], v[36:39]
    s_waitcnt lgkmcnt(5)
    v_mfma_f32_16x16x32_bf16 v[8:11], v[120:123], v[56:59], v[8:11]
    ds_read_b128 v[72:75], v200 offset:288
    v_mfma_f32_16x16x32_bf16 v[12:15], v[122:125], v[56:59], v[12:15]
    ds_read_b128 v[48:51], v201 offset:2448
    v_mfma_f32_16x16x32_bf16 v[16:19], v[124:127], v[56:59], v[16:19]
    v_mfma_f32_16x16x32_bf16 v[20:23], v[126:129], v[56:59], v[20:23]
    s_waitcnt lgkmcnt(6)
    v_mfma_f32_16x16x32_bf16 v[24:27], v[120:123], v[60:63], v[24:27]
    v_mfma_f32_16x16x32_bf16 v[28:31], v[122:125], v[60:63], v[28:31]
    v_mfma_f32_16x16x32_bf16 v[32:35], v[124:127], v[60:63], v[32:35]
    v_mfma_f32_16x16x32_bf16 v[36:39], v[126:129], v[60:63], v[36:39]
    s_waitcnt lgkmcnt(3)
    v_mfma_f32_16x16x32_bf16 v[8:11], v[124:127], v[40:43], v[8:11]
    ds_read_b128 v[76:79], v200 offset:304
    v_mfma_f32_16x16x32_bf16 v[12:15], v[126:129], v[40:43], v[12:15]
    ds_read_b128 v[52:55], v201 offset:2464
    v_mfma_f32_16x16x32_bf16 v[16:19], v[128:131], v[40:43], v[16:19]
    v_mfma_f32_16x16x32_bf16 v[20:23], v[130:133], v[40:43], v[20:23]
    s_cmp_lg_u32 s3, 0
    s_cbranch_scc1 L_w0_25
    s_lshr_b32 s82, s72, 1
    s_and_b32 s83, s82, 3
    s_mul_i32 s83, s83, 7
    s_lshr_b32 s82, s82, 2
    s_lshl_b32 s82, s82, 1
    v_min_u32 v250, 13, v1
    v_cmp_lt_u32 vcc, 6, v250
    s_nop 1
    v_cndmask_b32 v251, 0, 1, vcc
    v_mul_u32_u24 v252, 7, v251
    v_sub_u32 v250, v250, v252
    v_add_u32 v250, s83, v250
    v_lshl_add_u32 v250, v250, 3, v251
    v_add_u32 v250, s82, v250
    v_lshlrev_b32 v250, 7, v250
    v_add_u32 v250, 32768, v250
    buffer_load_dwordx2 v[252:253], v250, s[56:59], 0 offen sc1
L_w0_25:
    s_waitcnt lgkmcnt(4)
    v_mfma_f32_16x16x32_bf16 v[24:27], v[124:127], v[44:47], v[24:27]
    v_mfma_f32_16x16x32_bf16 v[28:31], v[126:129], v[44:47], v[28:31]
    v_mfma_f32_16x16x32_bf16 v[32:35], v[128:131], v[44:47], v[32:35]
    v_mfma_f32_16x16x32_bf16 v[36:39], v[130:133], v[44:47], v[36:39]
    s_waitcnt lgkmcnt(2)
    v_mfma_f32_16x16x32_bf16 v[8:11], v[64:67], v[48:51], v[8:11]
    ds_read_b128 v[80:83], v200 offset:320
    v_mfma_f32_16x16x32_bf16 v[12:15], v[66:69], v[48:51], v[12:15]
    ds_read_b128 v[56:59], v201 offset:2480
    v_mfma_f32_16x16x32_bf16 v[16:19], v[68:71], v[48:51], v[16:19]
    v_mfma_f32_16x16x32_bf16 v[20:23], v[70:73], v[48:51], v[20:23]
    s_waitcnt lgkmcnt(2)
    v_mfma_f32_16x16x32_bf16 v[8:11], v[68:71], v[52:55], v[8:11]
    ds_read_b128 v[84:87], v200 offset:336
    v_mfma_f32_16x16x32_bf16 v[12:15], v[70:73], v[52:55], v[12:15]
    ds_read_b128 v[60:63], v201 offset:2496
    v_mfma_f32_16x16x32_bf16 v[16:19], v[72:75], v[52:55], v[16:19]
    v_mfma_f32_16x16x32_bf16 v[20:23], v[74:77], v[52:55], v[20:23]
    s_waitcnt lgkmcnt(2)
    v_mfma_f32_16x16x32_bf16 v[8:11], v[72:75], v[56:59], v[8:11]
    ds_read_b128 v[88:91], v200 offset:352
    v_mfma_f32_16x16x32_bf16 v[12:15], v[74:77], v[56:59], v[12:15]
    ds_read_b128 v[40:43], v201 offset:2512
    v_mfma_f32_16x16x32_bf16 v[16:19], v[76:79], v[56:59], v[16:19]
    v_mfma_f32_16x16x32_bf16 v[20:23], v[78:81], v[56:59], v[20:23]
    s_waitcnt lgkmcnt(2)
    v_mfma_f32_16x16x32_bf16 v[8:11], v[76:79], v[60:63], v[8:11]
    ds_read_b128 v[92:95], v200 offset:368
    v_mfma_f32_16x16x32_bf16 v[12:15], v[78:81], v[60:63], v[12:15]
    ds_read_b128 v[44:47], v201 offset:2528
    v_mfma_f32_16x16x32_bf16 v[16:19], v[80:83], v[60:63], v[16:19]
    v_mfma_f32_16x16x32_bf16 v[20:23], v[82:85], v[60:63], v[20:23]
    s_waitcnt lgkmcnt(2)
    v_mfma_f32_16x16x32_bf16 v[8:11], v[80:83], v[40:43], v[8:11]
    ds_read_b128 v[96:99], v200 offset:384
    v_mfma_f32_16x16x32_bf16 v[12:15], v[82:85], v[40:43], v[12:15]
    ds_read_b128 v[48:51], v201 offset:2544
    v_mfma_f32_16x16x32_bf16 v[16:19], v[84:87], v[40:43], v[16:19]
    v_mfma_f32_16x16x32_bf16 v[20:23], v[86:89], v[40:43], v[20:23]
    s_waitcnt lgkmcnt(2)
    v_mfma_f32_16x16x32_bf16 v[8:11], v[84:87], v[44:47], v[8:11]
    ds_read_b128 v[100:103], v200 offset:400
    v_mfma_f32_16x16x32_bf16 v[12:15], v[86:89], v[44:47], v[12:15]
    ds_read_b128 v[52:55], v201 offset:2560
    v_mfma_f32_16x16x32_bf16 v[16:19], v[88:91], v[44:47], v[16:19]
    v_mfma_f32_16x16x32_bf16 v[20:23], v[90:93], v[44:47], v[20:23]
    s_cmp_lg_u32 s3, 0
    s_cbranch_scc1 L_w0_26
    s_waitcnt vmcnt(0)
    s_mov_b32 s95, 0
L_poll_27:
    v_cmp_ne_u32 vcc, s90, v252
    v_cmp_ne_u32 s[92:93], s91, v253
    s_nop 1
    s_or_b64 vcc, vcc, s[92:93]
    s_cmp_eq_u64 vcc, 0
    s_cbranch_scc1 L_poll_done_28
    s_add_u32 s95, s95, 1
    s_cmp_ge_u32 s95, 0x40000
    s_cbranch_scc1 L_poll_done_28
    buffer_load_dwordx2 v[252:253], v250, s[56:59], 0 offen sc1
    s_waitcnt vmcnt(0)
    s_branch L_poll_27
L_poll_done_28:
L_w0_26:
    s_barrier
    s_lshl_b32 s80, s72, 1
    s_add_u32 s81, s80, s87
    s_xor_b32 s82, s81, 1
    s_mul_i32 s83, s3, 28
    s_mul_i32 s8, s81, 112
    s_add_u32 s8, s8, s83
    s_lshl_b32 s8, s8, 10
    s_add_u32 s8, s8, 5242880
    s_mul_i32 s9, s82, 112
    s_add_u32 s9, s9, s83
    s_lshl_b32 s9, s9, 10
    s_add_u32 s9, s9, 5242880
    v_lshlrev_b32 v235, 4, v1
    s_waitcnt lgkmcnt(2)
    v_mfma_f32_16x16x32_bf16 v[8:11], v[88:91], v[48:51], v[8:11]
    ds_read_b128 v[104:107], v200 offset:416
    v_mfma_f32_16x16x32_bf16 v[12:15], v[90:93], v[48:51], v[12:15]
    ds_read_b128 v[56:59], v201 offset:2576
    v_mfma_f32_16x16x32_bf16 v[16:19], v[92:95], v[48:51], v[16:19]
    v_mfma_f32_16x16x32_bf16 v[20:23], v[94:97], v[48:51], v[20:23]
    buffer_load_dwordx4 v[136:139], v235, s[56:59], s8 offen offset:0 sc1
    buffer_load_dwordx4 v[140:143], v235, s[56:59], s9 offen offset:0 sc1
    s_waitcnt lgkmcnt(2)
    v_mfma_f32_16x16x32_bf16 v[8:11], v[92:95], v[52:55], v[8:11]
    ds_read_b128 v[108:111], v200 offset:432
    v_mfma_f32_16x16x32_bf16 v[12:15], v[94:97], v[52:55], v[12:15]
    ds_read_b128 v[60:63], v201 offset:2592
    v_mfma_f32_16x16x32_bf16 v[16:19], v[96:99], v[52:55], v[16:19]
    v_mfma_f32_16x16x32_bf16 v[20:23], v[98:101], v[52:55], v[20:23]
    buffer_load_dwordx4 v[144:147], v235, s[56:59], s8 offen offset:1024 sc1
    buffer_load_dwordx4 v[148:151], v235, s[56:59], s9 offen offset:1024 sc1
    s_waitcnt lgkmcnt(2)
    v_mfma_f32_16x16x32_bf16 v[8:11], v[96:99], v[56:59], v[8:11]
    ds_read_b128 v[112:115], v200 offset:448
    v_mfma_f32_16x16x32_bf16 v[12:15], v[98:101], v[56:59], v[12:15]
    ds_read_b128 v[40:43], v201 offset:2608
    v_mfma_f32_16x16x32_bf16 v[16:19], v[100:103], v[56:59], v[16:19]
    v_mfma_f32_16x16x32_bf16 v[20:23], v[102:105], v[56:59], v[20:23]
    buffer_load_dwordx4 v[152:155], v235, s[56:59], s8 offen offset:2048 sc1
    buffer_load_dwordx4 v[156:159], v235, s[56:59], s9 offen offset:2048 sc1
    s_waitcnt lgkmcnt(2)
    v_mfma_f32_16x16x32_bf16 v[8:11], v[100:103], v[60:63], v[8:11]
    ds_read_b128 v[116:119], v200 offset:464
    v_mfma_f32_16x16x32_bf16 v[12:15], v[102:105], v[60:63], v[12:15]
    ds_read_b128 v[44:47], v201 offset:2624
    v_mfma_f32_16x16x32_bf16 v[16:19], v[104:107], v[60:63], v[16:19]
    v_mfma_f32_16x16x32_bf16 v[20:23], v[106:109], v[60:63], v[20:23]
    buffer_load_dwordx4 v[160:163], v235, s[56:59], s8 offen offset:3072 sc1
    buffer_load_dwordx4 v[164:167], v235, s[56:59], s9 offen offset:3072 sc1
    s_waitcnt lgkmcnt(2)
    v_mfma_f32_16x16x32_bf16 v[8:11], v[104:107], v[40:43], v[8:11]
    ds_read_b128 v[120:123], v200 offset:480
    v_mfma_f32_16x16x32_bf16 v[12:15], v[106:109], v[40:43], v[12:15]
    ds_read_b128 v[48:51], v201 offset:2640
    v_mfma_f32_16x16x32_bf16 v[16:19], v[108:111], v[40:43], v[16:19]
    v_mfma_f32_16x16x32_bf16 v[20:23], v[110:113], v[40:43], v[20:23]
    s_add_u32 s8, s8, 4096
    buffer_load_dwordx4 v[168:171], v235, s[56:59], s8 offen offset:0 sc1
    s_add_u32 s9, s9, 4096
    buffer_load_dwordx4 v[172:175], v235, s[56:59], s9 offen offset:0 sc1
    s_waitcnt lgkmcnt(2)
    v_mfma_f32_16x16x32_bf16 v[8:11], v[108:111], v[44:47], v[8:11]
    ds_read_b128 v[124:127], v200 offset:496
    v_mfma_f32_16x16x32_bf16 v[12:15], v[110:113], v[44:47], v[12:15]
    ds_read_b128 v[52:55], v201 offset:2656
    v_mfma_f32_16x16x32_bf16 v[16:19], v[112:115], v[44:47], v[16:19]
    v_mfma_f32_16x16x32_bf16 v[20:23], v[114:117], v[44:47], v[20:23]
    buffer_load_dwordx4 v[176:179], v235, s[56:59], s8 offen offset:1024 sc1
    buffer_load_dwordx4 v[180:183], v235, s[56:59], s9 offen offset:1024 sc1
    s_waitcnt lgkmcnt(2)
    v_mfma_f32_16x16x32_bf16 v[8:11], v[112:115], v[48:51], v[8:11]
    ds_read_b128 v[64:67], v200 offset:512
    ds_read_b128 v[128:131], v200 offset:512
    v_mfma_f32_16x16x32_bf16 v[12:15], v[114:117], v[48:51], v[12:15]
    ds_read_b128 v[56:59], v201 offset:2672
    v_mfma_f32_16x16x32_bf16 v[16:19], v[116:119], v[48:51], v[16:19]
    v_mfma_f32_16x16x32_bf16 v[20:23], v[118:121], v[48:51], v[20:23]
    buffer_load_dwordx4 v[184:187], v235, s[56:59], s8 offen offset:2048 sc1
    buffer_load_dwordx4 v[188:191], v235, s[56:59], s9 offen offset:2048 sc1
    s_waitcnt lgkmcnt(3)
    v_mfma_f32_16x16x32_bf16 v[8:11], v[116:119], v[52:55], v[8:11]
    ds_read_b128 v[68:71], v200 offset:528
    ds_read_b128 v[132:135], v200 offset:528
    v_mfma_f32_16x16x32_bf16 v[12:15], v[118:121], v[52:55], v[12:15]
    ds_read_b128 v[60:63], v201 offset:2688
    v_mfma_f32_16x16x32_bf16 v[16:19], v[120:123], v[52:55], v[16:19]
    v_mfma_f32_16x16x32_bf16 v[20:23], v[122:125], v[52:55], v[20:23]
    s_waitcnt lgkmcnt(3)
    v_mfma_f32_16x16x32_bf16 v[8:11], v[120:123], v[56:59], v[8:11]
    v_mfma_f32_16x16x32_bf16 v[12:15], v[122:125], v[56:59], v[12:15]
    v_mfma_f32_16x16x32_bf16 v[16:19], v[124:127], v[56:59], v[16:19]
    v_mfma_f32_16x16x32_bf16 v[20:23], v[126:129], v[56:59], v[20:23]
    s_waitcnt lgkmcnt(0)
    v_mfma_f32_16x16x32_bf16 v[8:11], v[124:127], v[60:63], v[8:11]
    v_mfma_f32_16x16x32_bf16 v[12:15], v[126:129], v[60:63], v[12:15]
    v_mfma_f32_16x16x32_bf16 v[16:19], v[128:131], v[60:63], v[16:19]
    v_mfma_f32_16x16x32_bf16 v[20:23], v[130:133], v[60:63], v[20:23]
    s_lshl_b32 s80, s86, 12
    s_add_u32 s80, s80, 45056
    v_lshl_add_u32 v202, v1, 4, s80
    ds_write_b128 v202, v[24:27] offset:0
    ds_write_b128 v202, v[28:31] offset:1024
    ds_write_b128 v202, v[32:35] offset:2048
    ds_write_b128 v202, v[36:39] offset:3072
    s_waitcnt lgkmcnt(0)
    s_barrier
    s_branch L_cvJ_22
L_cvB_21:
    s_nop 7
    ds_read_b128 v[64:67], v200 offset:256
    ds_read_b128 v[68:71], v200 offset:272
    ds_read_b128 v[72:75], v200 offset:288
    ds_read_b128 v[40:43], v201 offset:272
    ds_read_b128 v[76:79], v200 offset:304
    ds_read_b128 v[44:47], v201 offset:288
    s_waitcnt lgkmcnt(2)
    v_mfma_f32_16x16x32_bf16 v[24:27], v[64:67], v[40:43], 0
    ds_read_b128 v[80:83], v200 offset:320
    v_mfma_f32_16x16x32_bf16 v[28:31], v[66:69], v[40:43], 0
    ds_read_b128 v[48:51], v201 offset:304
    v_mfma_f32_16x16x32_bf16 v[32:35], v[68:71], v[40:43], 0
    buffer_load_dwordx4 a[136:139], v235, s[56:59], s16 offen offset:2048 sc1
    v_mfma_f32_16x16x32_bf16 v[36:39], v[70:73], v[40:43], 0
    s_waitcnt lgkmcnt(2)
    v_mfma_f32_16x16x32_bf16 v[24:27], v[68:71], v[44:47], v[24:27]
    ds_read_b128 v[84:87], v200 offset:336
    v_mfma_f32_16x16x32_bf16 v[28:31], v[70:73], v[44:47], v[28:31]
    ds_read_b128 v[52:55], v201 offset:320
    v_mfma_f32_16x16x32_bf16 v[32:35], v[72:75], v[44:47], v[32:35]
    buffer_load_dwordx4 a[140:143], v235, s[56:59], s17 offen offset:2048 sc1
    v_mfma_f32_16x16x32_bf16 v[36:39], v[74:77], v[44:47], v[36:39]
    s_waitcnt lgkmcnt(2)
    v_mfma_f32_16x16x32_bf16 v[24:27], v[72:75], v[48:51], v[24:27]
    ds_read_b128 v[88:91], v200 offset:352
    v_mfma_f32_16x16x32_bf16 v[28:31], v[74:77], v[48:51], v[28:31]
    ds_read_b128 v[56:59], v201 offset:336
    v_mfma_f32_16x16x32_bf16 v[32:35], v[76:79], v[48:51], v[32:35]
    s_add_u32 s16, s16, 4096
    buffer_load_dwordx4 a[144:147], v235, s[56:59], s16 offen offset:0 sc1
    v_mfma_f32_16x16x32_bf16 v[36:39], v[78:81], v[48:51], v[36:39]
    s_waitcnt lgkmcnt(2)
    v_mfma_f32_16x16x32_bf16 v[24:27], v[76:79], v[52:55], v[24:27]
    ds_read_b128 v[92:95], v200 offset:368
    v_mfma_f32_16x16x32_bf16 v[28:31], v[78:81], v[52:55], v[28:31]
    ds_read_b128 v[60:63], v201 offset:352
    v_mfma_f32_16x16x32_bf16 v[32:35], v[80:83], v[52:55], v[32:35]
    s_add_u32 s17, s17, 4096
    buffer_load_dwordx4 a[148:151], v235, s[56:59], s17 offen offset:0 sc1
    v_mfma_f32_16x16x32_bf16 v[36:39], v[82:85], v[52:55], v[36:39]
    s_waitcnt lgkmcnt(2)
    v_mfma_f32_16x16x32_bf16 v[24:27], v[80:83], v[56:59], v[24:27]
    ds_read_b128 v[96:99], v200 offset:384
    v_mfma_f32_16x16x32_bf16 v[28:31], v[82:85], v[56:59], v[28:31]
    ds_read_b128 v[40:43], v201 offset:368
    v_mfma_f32_16x16x32_bf16 v[32:35], v[84:87], v[56:59], v[32:35]
    buffer_load_dwordx4 a[152:155], v235, s[56:59], s16 offen offset:2048 sc1
    v_mfma_f32_16x16x32_bf16 v[36:39], v[86:89], v[56:59], v[36:39]
    s_waitcnt lgkmcnt(2)
    v_mfma_f32_16x16x32_bf16 v[24:27], v[84:87], v[60:63], v[24:27]
    ds_read_b128 v[100:103], v200 offset:400
    v_mfma_f32_16x16x32_bf16 v[28:31], v[86:89], v[60:63], v[28:31]
    ds_read_b128 v[44:47], v201 offset:384
    v_mfma_f32_16x16x32_bf16 v[32:35], v[88:91], v[60:63], v[32:35]
    buffer_load_dwordx4 a[156:159], v235, s[56:59], s17 offen offset:2048 sc1
    v_mfma_f32_16x16x32_bf16 v[36:39], v[90:93], v[60:63], v[36:39]
    s_waitcnt lgkmcnt(2)
    v_mfma_f32_16x16x32_bf16 v[24:27], v[88:91], v[40:43], v[24:27]
    ds_read_b128 v[104:107], v200 offset:416
    v_mfma_f32_16x16x32_bf16 v[28:31], v[90:93], v[40:43], v[28:31]
    ds_read_b128 v[48:51], v201 offset:400
    v_mfma_f32_16x16x32_bf16 v[32:35], v[92:95], v[40:43], v[32:35]
    s_add_u32 s16, s16, 4096
    buffer_load_dwordx4 a[160:163], v235, s[56:59], s16 offen offset:0 sc1
    v_mfma_f32_16x16x32_bf16 v[36:39], v[94:97], v[40:43], v[36:39]
    s_waitcnt lgkmcnt(2)
    v_mfma_f32_16x16x32_bf16 v[24:27], v[92:95], v[44:47], v[24:27]
    ds_read_b128 v[108:111], v200 offset:432
    v_mfma_f32_16x16x32_bf16 v[28:31], v[94:97], v[44:47], v[28:31]
    ds_read_b128 v[52:55], v201 offset:416
    v_mfma_f32_16x16x32_bf16 v[32:35], v[96:99], v[44:47], v[32:35]
    s_add_u32 s17, s17, 4096
    buffer_load_dwordx4 a[164:167], v235, s[56:59], s17 offen offset:0 sc1
    v_mfma_f32_16x16x32_bf16 v[36:39], v[98:101], v[44:47], v[36:39]
    s_waitcnt lgkmcnt(2)
    v_mfma_f32_16x16x32_bf16 v[24:27], v[96:99], v[48:51], v[24:27]
    ds_read_b128 v[112:115], v200 offset:448
    v_mfma_f32_16x16x32_bf16 v[28:31], v[98:101], v[48:51], v[28:31]
    ds_read_b128 v[56:59], v201 offset:432
    v_mfma_f32_16x16x32_bf16 v[32:35], v[100:103], v[48:51], v[32:35]
    buffer_load_dwordx4 a[168:171], v235, s[56:59], s16 offen offset:2048 sc1
    v_mfma_f32_16x16x32_bf16 v[36:39], v[102:105], v[48:51], v[36:39]
    s_waitcnt lgkmcnt(2)
    v_mfma_f32_16x16x32_bf16 v[24:27], v[100:103], v[52:55], v[24:27]
    ds_read_b128 v[116:119], v200 offset:464
    v_mfma_f32_16x16x32_bf16 v[28:31], v[102:105], v[52:55], v[28:31]
    ds_read_b128 v[60:63], v201 offset:448
    v_mfma_f32_16x16x32_bf16 v[32:35], v[104:107], v[52:55], v[32:35]
    buffer_load_dwordx4 a[172:175], v235, s[56:59], s17 offen offset:2048 sc1
    v_mfma_f32_16x16x32_bf16 v[36:39], v[106:109], v[52:55], v[36:39]
    s_waitcnt lgkmcnt(2)
    v_mfma_f32_16x16x32_bf16 v[24:27], v[104:107], v[56:59], v[24:27]
    ds_read_b128 v[120:123], v200 offset:480
    v_mfma_f32_16x16x32_bf16 v[28:31], v[106:109], v[56:59], v[28:31]
    ds_read_b128 v[40:43], v201 offset:464
    v_mfma_f32_16x16x32_bf16 v[32:35], v[108:111], v[56:59], v[32:35]
    s_add_u32 s16, s16, 4096
    buffer_load_dwordx4 a[176:179], v235, s[56:59], s16 offen offset:0 sc1
    v_mfma_f32_16x16x32_bf16 v[36:39], v[110:113], v[56:59], v[36:39]
    s_waitcnt lgkmcnt(2)
    v_mfma_f32_16x16x32_bf16 v[24:27], v[108:111], v[60:63], v[24:27]
    ds_read_b128 v[124:127], v200 offset:496
    v_mfma_f32_16x16x32_bf16 v[28:31], v[110:113], v[60:63], v[28:31]
    ds_read_b128 v[44:47], v201 offset:480
    v_mfma_f32_16x16x32_bf16 v[32:35], v[112:115], v[60:63], v[32:35]
    s_add_u32 s17, s17, 4096
    buffer_load_dwordx4 a[180:183], v235, s[56:59], s17 offen offset:0 sc1
    v_mfma_f32_16x16x32_bf16 v[36:39], v[114:117], v[60:63], v[36:39]
    s_waitcnt vmcnt(12)
    s_barrier
    s_cmp_ge_u32 s76, 28
    s_cbranch_scc1 L_nosigB_29
    s_cmp_lg_u32 s3, 0
    s_cbranch_scc1 L_w0_30
    s_lshl_b32 s80, s2, 7
    s_add_u32 s80, s80, 32768
    v_mov_b32 v247, s80
    v_mov_b32 v244, s90
    v_mov_b32 v245, s91
    s_mov_b64 s[92:93], exec
    s_mov_b64 exec, 1
    buffer_store_dwordx2 v[244:245], v247, s[56:59], 0 offen sc1
    s_mov_b64 exec, s[92:93]
L_w0_30:
L_nosigB_29:
    s_waitcnt lgkmcnt(2)
    v_mfma_f32_16x16x32_bf16 v[24:27], v[112:115], v[40:43], v[24:27]
    ds_read_b128 v[64:67], v200 offset:512
    ds_read_b128 v[128:131], v200 offset:512
    v_mfma_f32_16x16x32_bf16 v[28:31], v[114:117], v[40:43], v[28:31]
    ds_read_b128 v[48:51], v201 offset:496
    v_mfma_f32_16x16x32_bf16 v[32:35], v[116:119], v[40:43], v[32:35]
    buffer_load_dwordx4 a[184:187], v235, s[56:59], s16 offen offset:2048 sc1
    v_mfma_f32_16x16x32_bf16 v[36:39], v[118:121], v[40:43], v[36:39]
    s_waitcnt lgkmcnt(3)
    v_mfma_f32_16x16x32_bf16 v[24:27], v[116:119], v[44:47], v[24:27]
    ds_read_b128 v[68:71], v200 offset:528
    ds_read_b128 v[132:135], v200 offset:528
    v_mfma_f32_16x16x32_bf16 v[28:31], v[118:121], v[44:47], v[28:31]
    ds_read_b128 v[52:55], v201 offset:512
    v_mfma_f32_16x16x32_bf16 v[32:35], v[120:123], v[44:47], v[32:35]
    buffer_load_dwordx4 a[188:191], v235, s[56:59], s17 offen offset:2048 sc1
    v_mfma_f32_16x16x32_bf16 v[36:39], v[122:125], v[44:47], v[36:39]
    s_waitcnt lgkmcnt(3)
    v_mfma_f32_16x16x32_bf16 v[24:27], v[120:123], v[48:51], v[24:27]
    ds_read_b128 v[72:75], v200 offset:2048
    ds_read_b128 v[76:79], v200 offset:2064
    ds_read_b128 v[80:83], v200 offset:2080
    v_mfma_f32_16x16x32_bf16 v[28:31], v[122:125], v[48:51], v[28:31]
    ds_read_b128 v[56:59], v201 offset:2176
    v_mfma_f32_16x16x32_bf16 v[32:35], v[124:127], v[48:51], v[32:35]
    s_add_u32 s16, s16, 4096
    buffer_load_dwordx4 a[192:195], v235, s[56:59], s16 offen offset:0 sc1
    v_mfma_f32_16x16x32_bf16 v[36:39], v[126:129], v[48:51], v[36:39]
    s_waitcnt lgkmcnt(4)
    v_mfma_f32_16x16x32_bf16 v[24:27], v[124:127], v[52:55], v[24:27]
    ds_read_b128 v[84:87], v200 offset:2096
    v_mfma_f32_16x16x32_bf16 v[28:31], v[126:129], v[52:55], v[28:31]
    ds_read_b128 v[60:63], v201 offset:2192
    v_mfma_f32_16x16x32_bf16 v[32:35], v[128:131], v[52:55], v[32:35]
    s_add_u32 s17, s17, 4096
    buffer_load_dwordx4 a[196:199], v235, s[56:59], s17 offen offset:0 sc1
    v_mfma_f32_16x16x32_bf16 v[36:39], v[130:133], v[52:55], v[36:39]
    s_waitcnt lgkmcnt(2)
    v_mfma_f32_16x16x32_bf16 v[24:27], v[72:75], v[56:59], v[24:27]
    ds_read_b128 v[88:91], v200 offset:2112
    v_mfma_f32_16x16x32_bf16 v[28:31], v[74:77], v[56:59], v[28:31]
    ds_read_b128 v[40:43], v201 offset:2208
    v_mfma_f32_16x16x32_bf16 v[32:35], v[76:79], v[56:59], v[32:35]
    buffer_load_dwordx4 a[200:203], v235, s[56:59], s16 offen offset:2048 sc1
    v_mfma_f32_16x16x32_bf16 v[36:39], v[78:81], v[56:59], v[36:39]
    s_waitcnt lgkmcnt(2)
    v_mfma_f32_16x16x32_bf16 v[24:27], v[76:79], v[60:63], v[24:27]
    ds_read_b128 v[92:95], v200 offset:2128
    v_mfma_f32_16x16x32_bf16 v[28:31], v[78:81], v[60:63], v[28:31]
    ds_read_b128 v[44:47], v201 offset:2224
    v_mfma_f32_16x16x32_bf16 v[32:35], v[80:83], v[60:63], v[32:35]
    buffer_load_dwordx4 a[204:207], v235, s[56:59], s17 offen offset:2048 sc1
    v_mfma_f32_16x16x32_bf16 v[36:39], v[82:85], v[60:63], v[36:39]
    s_waitcnt lgkmcnt(2)
    v_mfma_f32_16x16x32_bf16 v[24:27], v[80:83], v[40:43], v[24:27]
    ds_read_b128 v[96:99], v200 offset:2144
    v_mfma_f32_16x16x32_bf16 v[28:31], v[82:85], v[40:43], v[28:31]
    ds_read_b128 v[48:51], v201 offset:2240
    v_mfma_f32_16x16x32_bf16 v[32:35], v[84:87], v[40:43], v[32:35]
    s_add_u32 s16, s16, 4096
    buffer_load_dwordx4 a[208:211], v235, s[56:59], s16 offen offset:0 sc1
    v_mfma_f32_16x16x32_bf16 v[36:39], v[86:89], v[40:43], v[36:39]
    s_waitcnt lgkmcnt(2)
    v_mfma_f32_16x16x32_bf16 v[24:27], v[84:87], v[44:47], v[24:27]
    ds_read_b128 v[100:103], v200 offset:2160
    v_mfma_f32_16x16x32_bf16 v[28:31], v[86:89], v[44:47], v[28:31]
    ds_read_b128 v[52:55], v201 offset:2256
    v_mfma_f32_16x16x32_bf16 v[32:35], v[88:91], v[44:47], v[32:35]
    s_add_u32 s17, s17, 4096
    buffer_load_dwordx4 a[212:215], v235, s[56:59], s17 offen offset:0 sc1
    v_mfma_f32_16x16x32_bf16 v[36:39], v[90:93], v[44:47], v[36:39]
    s_waitcnt lgkmcnt(2)
    v_mfma_f32_16x16x32_bf16 v[24:27], v[88:91], v[48:51], v[24:27]
    ds_read_b128 v[104:107], v200 offset:2176
    v_mfma_f32_16x16x32_bf16 v[28:31], v[90:93], v[48:51], v[28:31]
    ds_read_b128 v[56:59], v201 offset:2272
    v_mfma_f32_16x16x32_bf16 v[32:35], v[92:95], v[48:51], v[32:35]
    buffer_load_dwordx4 a[216:219], v235, s[56:59], s16 offen offset:2048 sc1
    v_mfma_f32_16x16x32_bf16 v[36:39], v[94:97], v[48:51], v[36:39]
    s_waitcnt lgkmcnt(2)
    v_mfma_f32_16x16x32_bf16 v[24:27], v[92:95], v[52:55], v[24:27]
    ds_read_b128 v[108:111], v200 offset:2192
    v_mfma_f32_16x16x32_bf16 v[28:31], v[94:97], v[52:55], v[28:31]
    ds_read_b128 v[60:63], v201 offset:2288
    v_mfma_f32_16x16x32_bf16 v[32:35], v[96:99], v[52:55], v[32:35]
    buffer_load_dwordx4 a[220:223], v235, s[56:59], s17 offen offset:2048 sc1
    v_mfma_f32_16x16x32_bf16 v[36:39], v[98:101], v[52:55], v[36:39]
    s_waitcnt lgkmcnt(2)
    v_mfma_f32_16x16x32_bf16 v[24:27], v[96:99], v[56:59], v[24:27]
    ds_read_b128 v[112:115], v200 offset:2208
    v_mfma_f32_16x16x32_bf16 v[28:31], v[98:101], v[56:59], v[28:31]
    ds_read_b128 v[40:43], v201 offset:2304
    v_mfma_f32_16x16x32_bf16 v[32:35], v[100:103], v[56:59], v[32:35]
    v_mfma_f32_16x16x32_bf16 v[36:39], v[102:105], v[56:59], v[36:39]
    s_waitcnt lgkmcnt(2)
    v_mfma_f32_16x16x32_bf16 v[24:27], v[100:103], v[60:63], v[24:27]
    ds_read_b128 v[116:119], v200 offset:2224
    v_mfma_f32_16x16x32_bf16 v[28:31], v[102:105], v[60:63], v[28:31]
    ds_read_b128 v[44:47], v201 offset:2320
    v_mfma_f32_16x16x32_bf16 v[32:35], v[104:107], v[60:63], v[32:35]
    v_mfma_f32_16x16x32_bf16 v[36:39], v[106:109], v[60:63], v[36:39]
    s_waitcnt lgkmcnt(2)
    v_mfma_f32_16x16x32_bf16 v[24:27], v[104:107], v[40:43], v[24:27]
    ds_read_b128 v[120:123], v200 offset:2240
    v_mfma_f32_16x16x32_bf16 v[28:31], v[106:109], v[40:43], v[28:31]
    ds_read_b128 v[48:51], v201 offset:2336
    v_mfma_f32_16x16x32_bf16 v[32:35], v[108:111], v[40:43], v[32:35]
    v_mfma_f32_16x16x32_bf16 v[36:39], v[110:113], v[40:43], v[36:39]
    s_waitcnt lgkmcnt(2)
    v_mfma_f32_16x16x32_bf16 v[24:27], v[108:111], v[44:47], v[24:27]
    ds_read_b128 v[124:127], v200 offset:2256
    v_mfma_f32_16x16x32_bf16 v[28:31], v[110:113], v[44:47], v[28:31]
    ds_read_b128 v[52:55], v201 offset:2352
    v_mfma_f32_16x16x32_bf16 v[32:35], v[112:115], v[44:47], v[32:35]
    v_mfma_f32_16x16x32_bf16 v[36:39], v[114:117], v[44:47], v[36:39]
    s_waitcnt lgkmcnt(2)
    v_mfma_f32_16x16x32_bf16 v[24:27], v[112:115], v[48:51], v[24:27]
    ds_read_b128 v[64:67], v200 offset:2272
    ds_read_b128 v[128:131], v200 offset:2272
    v_mfma_f32_16x16x32_bf16 v[28:31], v[114:117], v[48:51], v[28:31]
    ds_read_b128 v[56:59], v201 offset:2368
    v_mfma_f32_16x16x32_bf16 v[32:35], v[116:119], v[48:51], v[32:35]
    v_mfma_f32_16x16x32_bf16 v[36:39], v[118:121], v[48:51], v[36:39]
    s_waitcnt lgkmcnt(3)
    v_mfma_f32_16x16x32_bf16 v[24:27], v[116:119], v[52:55], v[24:27]
    ds_read_b128 v[68:71], v200 offset:2288
    ds_read_b128 v[132:135], v200 offset:2288
    v_mfma_f32_16x16x32_bf16 v[28:31], v[118:121], v[52:55], v[28:31]
    ds_read_b128 v[60:63], v201 offset:2384
    v_mfma_f32_16x16x32_bf16 v[32:35], v[120:123], v[52:55], v[32:35]
    v_mfma_f32_16x16x32_bf16 v[36:39], v[122:125], v[52:55], v[36:39]
    s_waitcnt lgkmcnt(3)
    v_mfma_f32_16x16x32_bf16 v[24:27], v[120:123], v[56:59], v[24:27]
    ds_read_b128 v[72:75], v200 offset:2304
    v_mfma_f32_16x16x32_bf16 v[28:31], v[122:125], v[56:59], v[28:31]
    ds_read_b128 v[40:43], v201 offset:2400
    v_mfma_f32_16x16x32_bf16 v[32:35], v[124:127], v[56:59], v[32:35]
    v_mfma_f32_16x16x32_bf16 v[36:39], v[126:129], v[56:59], v[36:39]
    s_waitcnt lgkmcnt(2)
    v_mfma_f32_16x16x32_bf16 v[24:27], v[124:127], v[60:63], v[24:27]
    ds_read_b128 v[76:79], v200 offset:2320
    v_mfma_f32_16x16x32_bf16 v[28:31], v[126:129], v[60:63], v[28:31]
    ds_read_b128 v[44:47], v201 offset:2416
    v_mfma_f32_16x16x32_bf16 v[32:35], v[128:131], v[60:63], v[32:35]
    v_mfma_f32_16x16x32_bf16 v[36:39], v[130:133], v[60:63], v[36:39]
    s_waitcnt lgkmcnt(2)
    v_mfma_f32_16x16x32_bf16 v[24:27], v[64:67], v[40:43], v[24:27]
    ds_read_b128 v[80:83], v200 offset:2336
    v_mfma_f32_16x16x32_bf16 v[28:31], v[66:69], v[40:43], v[28:31]
    ds_read_b128 v[48:51], v201 offset:2448
    v_mfma_f32_16x16x32_bf16 v[32:35], v[68:71], v[40:43], v[32:35]
    v_mfma_f32_16x16x32_bf16 v[36:39], v[70:73], v[40:43], v[36:39]
    s_cmp_lg_u32 s3, 0
    s_cbranch_scc1 L_w0_31
    s_lshr_b32 s82, s72, 1
    s_and_b32 s83, s82, 3
    s_mul_i32 s83, s83, 7
    s_lshr_b32 s82, s82, 2
    s_lshl_b32 s82, s82, 1
    v_min_u32 v250, 13, v1
    v_cmp_lt_u32 vcc, 6, v250
    s_nop 1
    v_cndmask_b32 v251, 0, 1, vcc
    v_mul_u32_u24 v252, 7, v251
    v_sub_u32 v250, v250, v252
    v_add_u32 v250, s83, v250
    v_lshl_add_u32 v250, v250, 3, v251
    v_add_u32 v250, s82, v250
    v_lshlrev_b32 v250, 7, v250
    v_add_u32 v250, 32768, v250
    buffer_load_dwordx2 v[252:253], v250, s[56:59], 0 offen sc1
L_w0_31:
    s_waitcnt lgkmcnt(2)
    v_mfma_f32_16x16x32_bf16 v[24:27], v[68:71], v[44:47], v[24:27]
    ds_read_b128 v[84:87], v200 offset:2352
    v_mfma_f32_16x16x32_bf16 v[28:31], v[70:73], v[44:47], v[28:31]
    ds_read_b128 v[52:55], v201 offset:2464
    v_mfma_f32_16x16x32_bf16 v[32:35], v[72:75], v[44:47], v[32:35]
    v_mfma_f32_16x16x32_bf16 v[36:39], v[74:77], v[44:47], v[36:39]
    s_waitcnt lgkmcnt(2)
    v_mfma_f32_16x16x32_bf16 v[24:27], v[72:75], v[48:51], v[24:27]
    ds_read_b128 v[88:91], v200 offset:2368
    v_mfma_f32_16x16x32_bf16 v[28:31], v[74:77], v[48:51], v[28:31]
    ds_read_b128 v[56:59], v201 offset:2480
    v_mfma_f32_16x16x32_bf16 v[32:35], v[76:79], v[48:51], v[32:35]
    v_mfma_f32_16x16x32_bf16 v[36:39], v[78:81], v[48:51], v[36:39]
    s_waitcnt lgkmcnt(2)
    v_mfma_f32_16x16x32_bf16 v[24:27], v[76:79], v[52:55], v[24:27]
    ds_read_b128 v[92:95], v200 offset:2384
    v_mfma_f32_16x16x32_bf16 v[28:31], v[78:81], v[52:55], v[28:31]
    ds_read_b128 v[60:63], v201 offset:2496
    v_mfma_f32_16x16x32_bf16 v[32:35], v[80:83], v[52:55], v[32:35]
    v_mfma_f32_16x16x32_bf16 v[36:39], v[82:85], v[52:55], v[36:39]
    s_waitcnt lgkmcnt(2)
    v_mfma_f32_16x16x32_bf16 v[24:27], v[80:83], v[56:59], v[24:27]
    ds_read_b128 v[96:99], v200 offset:2400
    v_mfma_f32_16x16x32_bf16 v[28:31], v[82:85], v[56:59], v[28:31]
    ds_read_b128 v[40:43], v201 offset:2512
    v_mfma_f32_16x16x32_bf16 v[32:35], v[84:87], v[56:59], v[32:35]
    v_mfma_f32_16x16x32_bf16 v[36:39], v[86:89], v[56:59], v[36:39]
    s_waitcnt lgkmcnt(2)
    v_mfma_f32_16x16x32_bf16 v[24:27], v[84:87], v[60:63], v[24:27]
    ds_read_b128 v[100:103], v200 offset:2416
    v_mfma_f32_16x16x32_bf16 v[28:31], v[86:89], v[60:63], v[28:31]
    ds_read_b128 v[44:47], v201 offset:2528
    v_mfma_f32_16x16x32_bf16 v[32:35], v[88:91], v[60:63], v[32:35]
    v_mfma_f32_16x16x32_bf16 v[36:39], v[90:93], v[60:63], v[36:39]
    s_waitcnt lgkmcnt(2)
    v_mfma_f32_16x16x32_bf16 v[24:27], v[88:91], v[40:43], v[24:27]
    ds_read_b128 v[104:107], v200 offset:2432
    v_mfma_f32_16x16x32_bf16 v[28:31], v[90:93], v[40:43], v[28:31]
    ds_read_b128 v[48:51], v201 offset:2544
    v_mfma_f32_16x16x32_bf16 v[32:35], v[92:95], v[40:43], v[32:35]
    v_mfma_f32_16x16x32_bf16 v[36:39], v[94:97], v[40:43], v[36:39]
    s_waitcnt lgkmcnt(2)
    v_mfma_f32_16x16x32_bf16 v[24:27], v[92:95], v[44:47], v[24:27]
    ds_read_b128 v[108:111], v200 offset:2448
    v_mfma_f32_16x16x32_bf16 v[28:31], v[94:97], v[44:47], v[28:31]
    ds_read_b128 v[52:55], v201 offset:2560
    v_mfma_f32_16x16x32_bf16 v[32:35], v[96:99], v[44:47], v[32:35]
    v_mfma_f32_16x16x32_bf16 v[36:39], v[98:101], v[44:47], v[36:39]
    s_cmp_lg_u32 s3, 0
    s_cbranch_scc1 L_w0_32
    s_waitcnt vmcnt(0)
    s_mov_b32 s95, 0
L_poll_33:
    v_cmp_ne_u32 vcc, s90, v252
    v_cmp_ne_u32 s[92:93], s91, v253
    s_nop 1
    s_or_b64 vcc, vcc, s[92:93]
    s_cmp_eq_u64 vcc, 0
    s_cbranch_scc1 L_poll_done_34
    s_add_u32 s95, s95, 1
    s_cmp_ge_u32 s95, 0x40000
    s_cbranch_scc1 L_poll_done_34
    buffer_load_dwordx2 v[252:253], v250, s[56:59], 0 offen sc1
    s_waitcnt vmcnt(0)
    s_branch L_poll_33
L_poll_done_34:
L_w0_32:
    s_barrier
    s_lshl_b32 s80, s72, 1
    s_add_u32 s81, s80, s87
    s_xor_b32 s82, s81, 1
    s_mul_i32 s83, s3, 28
    s_mul_i32 s8, s81, 112
    s_add_u32 s8, s8, s83
    s_lshl_b32 s8, s8, 10
    s_add_u32 s8, s8, 5242880
    s_mul_i32 s9, s82, 112
    s_add_u32 s9, s9, s83
    s_lshl_b32 s9, s9, 10
    s_add_u32 s9, s9, 5242880
    v_lshlrev_b32 v235, 4, v1
    s_waitcnt lgkmcnt(2)
    v_mfma_f32_16x16x32_bf16 v[24:27], v[96:99], v[48:51], v[24:27]
    ds_read_b128 v[112:115], v200 offset:2464
    v_mfma_f32_16x16x32_bf16 v[28:31], v[98:101], v[48:51], v[28:31]
    ds_read_b128 v[56:59], v201 offset:2576
    v_mfma_f32_16x16x32_bf16 v[32:35], v[100:103], v[48:51], v[32:35]
    v_mfma_f32_16x16x32_bf16 v[36:39], v[102:105], v[48:51], v[36:39]
    buffer_load_dwordx4 v[136:139], v235, s[56:59], s8 offen offset:0 sc1
    buffer_load_dwordx4 v[140:143], v235, s[56:59], s9 offen offset:0 sc1
    s_waitcnt lgkmcnt(2)
    v_mfma_f32_16x16x32_bf16 v[24:27], v[100:103], v[52:55], v[24:27]
    ds_read_b128 v[116:119], v200 offset:2480
    v_mfma_f32_16x16x32_bf16 v[28:31], v[102:105], v[52:55], v[28:31]
    ds_read_b128 v[60:63], v201 offset:2592
    v_mfma_f32_16x16x32_bf16 v[32:35], v[104:107], v[52:55], v[32:35]
    v_mfma_f32_16x16x32_bf16 v[36:39], v[106:109], v[52:55], v[36:39]
    buffer_load_dwordx4 v[144:147], v235, s[56:59], s8 offen offset:1024 sc1
    buffer_load_dwordx4 v[148:151], v235, s[56:59], s9 offen offset:1024 sc1
    s_waitcnt lgkmcnt(2)
    v_mfma_f32_16x16x32_bf16 v[24:27], v[104:107], v[56:59], v[24:27]
    ds_read_b128 v[120:123], v200 offset:2496
    v_mfma_f32_16x16x32_bf16 v[28:31], v[106:109], v[56:59], v[28:31]
    ds_read_b128 v[40:43], v201 offset:2608
    v_mfma_f32_16x16x32_bf16 v[32:35], v[108:111], v[56:59], v[32:35]
    v_mfma_f32_16x16x32_bf16 v[36:39], v[110:113], v[56:59], v[36:39]
    buffer_load_dwordx4 v[152:155], v235, s[56:59], s8 offen offset:2048 sc1
    buffer_load_dwordx4 v[156:159], v235, s[56:59], s9 offen offset:2048 sc1
    s_waitcnt lgkmcnt(2)
    v_mfma_f32_16x16x32_bf16 v[24:27], v[108:111], v[60:63], v[24:27]
    ds_read_b128 v[124:127], v200 offset:2512
    v_mfma_f32_16x16x32_bf16 v[28:31], v[110:113], v[60:63], v[28:31]
    ds_read_b128 v[44:47], v201 offset:2624
    v_mfma_f32_16x16x32_bf16 v[32:35], v[112:115], v[60:63], v[32:35]
    v_mfma_f32_16x16x32_bf16 v[36:39], v[114:117], v[60:63], v[36:39]
    buffer_load_dwordx4 v[160:163], v235, s[56:59], s8 offen offset:3072 sc1
    buffer_load_dwordx4 v[164:167], v235, s[56:59], s9 offen offset:3072 sc1
    s_waitcnt lgkmcnt(2)
    v_mfma_f32_16x16x32_bf16 v[24:27], v[112:115], v[40:43], v[24:27]
    ds_read_b128 v[64:67], v200 offset:2528
    ds_read_b128 v[128:131], v200 offset:2528
    v_mfma_f32_16x16x32_bf16 v[28:31], v[114:117], v[40:43], v[28:31]
    ds_read_b128 v[48:51], v201 offset:2640
    v_mfma_f32_16x16x32_bf16 v[32:35], v[116:119], v[40:43], v[32:35]
    v_mfma_f32_16x16x32_bf16 v[36:39], v[118:121], v[40:43], v[36:39]
    s_add_u32 s8, s8, 4096
    buffer_load_dwordx4 v[168:171], v235, s[56:59], s8 offen offset:0 sc1
    s_add_u32 s9, s9, 4096
    buffer_load_dwordx4 v[172:175], v235, s[56:59], s9 offen offset:0 sc1
    s_waitcnt lgkmcnt(3)
    v_mfma_f32_16x16x32_bf16 v[24:27], v[116:119], v[44:47], v[24:27]
    ds_read_b128 v[68:71], v200 offset:2544
    ds_read_b128 v[132:135], v200 offset:2544
    v_mfma_f32_16x16x32_bf16 v[28:31], v[118:121], v[44:47], v[28:31]
    ds_read_b128 v[52:55], v201 offset:2656
    v_mfma_f32_16x16x32_bf16 v[32:35], v[120:123], v[44:47], v[32:35]
    v_mfma_f32_16x16x32_bf16 v[36:39], v[122:125], v[44:47], v[36:39]
    buffer_load_dwordx4 v[176:179], v235, s[56:59], s8 offen offset:1024 sc1
    buffer_load_dwordx4 v[180:183], v235, s[56:59], s9 offen offset:1024 sc1
    s_waitcnt lgkmcnt(3)
    v_mfma_f32_16x16x32_bf16 v[24:27], v[120:123], v[48:51], v[24:27]
    ds_read_b128 v[72:75], v200 offset:2560
    v_mfma_f32_16x16x32_bf16 v[28:31], v[122:125], v[48:51], v[28:31]
    ds_read_b128 v[56:59], v201 offset:2672
    v_mfma_f32_16x16x32_bf16 v[32:35], v[124:127], v[48:51], v[32:35]
    v_mfma_f32_16x16x32_bf16 v[36:39], v[126:129], v[48:51], v[36:39]
    buffer_load_dwordx4 v[184:187], v235, s[56:59], s8 offen offset:2048 sc1
    buffer_load_dwordx4 v[188:191], v235, s[56:59], s9 offen offset:2048 sc1
    s_waitcnt lgkmcnt(2)
    v_mfma_f32_16x16x32_bf16 v[24:27], v[124:127], v[52:55], v[24:27]
    ds_read_b128 v[76:79], v200 offset:2576
    v_mfma_f32_16x16x32_bf16 v[28:31], v[126:129], v[52:55], v[28:31]
    ds_read_b128 v[60:63], v201 offset:2688
    v_mfma_f32_16x16x32_bf16 v[32:35], v[128:131], v[52:55], v[32:35]
    v_mfma_f32_16x16x32_bf16 v[36:39], v[130:133], v[52:55], v[36:39]
    s_waitcnt lgkmcnt(2)
    v_mfma_f32_16x16x32_bf16 v[24:27], v[64:67], v[56:59], v[24:27]
    v_mfma_f32_16x16x32_bf16 v[28:31], v[66:69], v[56:59], v[28:31]
    v_mfma_f32_16x16x32_bf16 v[32:35], v[68:71], v[56:59], v[32:35]
    v_mfma_f32_16x16x32_bf16 v[36:39], v[70:73], v[56:59], v[36:39]
    s_waitcnt lgkmcnt(0)
    v_mfma_f32_16x16x32_bf16 v[24:27], v[68:71], v[60:63], v[24:27]
    v_mfma_f32_16x16x32_bf16 v[28:31], v[70:73], v[60:63], v[28:31]
    v_mfma_f32_16x16x32_bf16 v[32:35], v[72:75], v[60:63], v[32:35]
    v_mfma_f32_16x16x32_bf16 v[36:39], v[74:77], v[60:63], v[36:39]
    s_lshl_b32 s80, s86, 12
    s_add_u32 s80, s80, 45056
    v_lshl_add_u32 v202, v1, 4, s80
    s_waitcnt lgkmcnt(0)
    s_barrier
    ds_read_b128 v[8:11], v202 offset:0
    ds_read_b128 v[12:15], v202 offset:1024
    ds_read_b128 v[16:19], v202 offset:2048
    ds_read_b128 v[20:23], v202 offset:3072
    s_waitcnt lgkmcnt(3)
    v_pk_add_f32 v[8:9], v[8:9], v[24:25]
    v_pk_add_f32 v[10:11], v[10:11], v[26:27]
    s_waitcnt lgkmcnt(2)
    v_pk_add_f32 v[12:13], v[12:13], v[28:29]
    v_pk_add_f32 v[14:15], v[14:15], v[30:31]
    s_waitcnt lgkmcnt(1)
    v_pk_add_f32 v[16:17], v[16:17], v[32:33]
    v_pk_add_f32 v[18:19], v[18:19], v[34:35]
    s_waitcnt lgkmcnt(0)
    v_pk_add_f32 v[20:21], v[20:21], v[36:37]
    v_pk_add_f32 v[22:23], v[22:23], v[38:39]
L_cvJ_22:
    s_nop 7
    s_mul_i32 s80, s3, 2304
    s_add_u32 s80, s80, 53248
    v_bfe_u32 v203, v1, 1, 3
    v_mul_u32_u24 v203, 272, v203
    v_lshrrev_b32 v204, 4, v1
    v_lshl_add_u32 v203, v204, 6, v203
    v_and_b32 v205, 1, v1
    v_lshl_add_u32 v203, v205, 2, v203
    v_add_u32 v203, s80, v203
    v_cvt_pk_bf16_f32 v40, v8, v9
    v_cvt_pk_bf16_f32 v41, v10, v11
    v_cvt_pk_bf16_f32 v42, v12, v13
    v_cvt_pk_bf16_f32 v43, v14, v15
    v_cvt_pk_bf16_f32 v44, v16, v17
    v_cvt_pk_bf16_f32 v45, v18, v19
    v_cvt_pk_bf16_f32 v46, v20, v21
    v_cvt_pk_bf16_f32 v47, v22, v23
    ds_write_b32 v203, v40 offset:0
    ds_write_b32 v203, v41 offset:32
    ds_write_b32 v203, v42 offset:8
    ds_write_b32 v203, v43 offset:40
    ds_write_b32 v203, v44 offset:16
    ds_write_b32 v203, v45 offset:48
    ds_write_b32 v203, v46 offset:24
    ds_write_b32 v203, v47 offset:56
    v_add_u32 v204, v204, v1
    v_lshl_add_u32 v204, v204, 4, s80
    s_waitcnt lgkmcnt(0)
    ds_read_b128 v[48:51], v204 offset:0
    ds_read_b128 v[52:55], v204 offset:1088
    s_lshl_b32 s80, s89, 12
    s_lshl_b32 s81, s87, 11
    s_add_u32 s80, s80, s81
    s_add_u32 s80, s80, 3145728
    v_lshlrev_b32 v205, 4, v1
    s_waitcnt lgkmcnt(1)
    buffer_store_dwordx4 v[48:51], v205, s[56:59], s80 offen offset:0 sc1
    s_waitcnt lgkmcnt(0)
    buffer_store_dwordx4 v[52:55], v205, s[56:59], s80 offen offset:1024 sc1
    s_waitcnt vmcnt(14)
    v_mfma_f32_32x32x16_bf16 v[64:79], a[0:3], v[136:139], 0
    v_mfma_f32_32x32x16_bf16 v[80:95], a[0:3], v[140:143], 0
    v_mfma_f32_32x32x16_bf16 v[96:111], a[4:7], v[136:139], 0
    v_mfma_f32_32x32x16_bf16 v[112:127], a[4:7], v[140:143], 0
    buffer_load_dwordx4 v[192:195], v235, s[56:59], s8 offen offset:3072 sc1
    buffer_load_dwordx4 v[196:199], v235, s[56:59], s9 offen offset:3072 sc1
    s_waitcnt vmcnt(14)
    v_mfma_f32_32x32x16_bf16 v[64:79], a[8:11], v[144:147], v[64:79]
    s_add_u32 s8, s8, 4096
    buffer_load_dwordx4 v[136:139], v235, s[56:59], s8 offen offset:0 sc1
    v_mfma_f32_32x32x16_bf16 v[80:95], a[8:11], v[148:151], v[80:95]
    s_add_u32 s9, s9, 4096
    buffer_load_dwordx4 v[140:143], v235, s[56:59], s9 offen offset:0 sc1
    v_mfma_f32_32x32x16_bf16 v[96:111], a[12:15], v[144:147], v[96:111]
    v_mfma_f32_32x32x16_bf16 v[112:127], a[12:15], v[148:151], v[112:127]
    s_waitcnt vmcnt(14)
    v_mfma_f32_32x32x16_bf16 v[64:79], a[16:19], v[152:155], v[64:79]
    buffer_load_dwordx4 v[144:147], v235, s[56:59], s8 offen offset:1024 sc1
    v_mfma_f32_32x32x16_bf16 v[80:95], a[16:19], v[156:159], v[80:95]
    buffer_load_dwordx4 v[148:151], v235, s[56:59], s9 offen offset:1024 sc1
    v_mfma_f32_32x32x16_bf16 v[96:111], a[20:23], v[152:155], v[96:111]
    v_mfma_f32_32x32x16_bf16 v[112:127], a[20:23], v[156:159], v[112:127]
    s_waitcnt vmcnt(14)
    v_mfma_f32_32x32x16_bf16 v[64:79], a[24:27], v[160:163], v[64:79]
    buffer_load_dwordx4 v[152:155], v235, s[56:59], s8 offen offset:2048 sc1
    v_mfma_f32_32x32x16_bf16 v[80:95], a[24:27], v[164:167], v[80:95]
    buffer_load_dwordx4 v[156:159], v235, s[56:59], s9 offen offset:2048 sc1
    v_mfma_f32_32x32x16_bf16 v[96:111], a[28:31], v[160:163], v[96:111]
    v_mfma_f32_32x32x16_bf16 v[112:127], a[28:31], v[164:167], v[112:127]
    s_waitcnt vmcnt(14)
    v_mfma_f32_32x32x16_bf16 v[64:79], a[32:35], v[168:171], v[64:79]
    buffer_load_dwordx4 v[160:163], v235, s[56:59], s8 offen offset:3072 sc1
    v_mfma_f32_32x32x16_bf16 v[80:95], a[32:35], v[172:175], v[80:95]
    buffer_load_dwordx4 v[164:167], v235, s[56:59], s9 offen offset:3072 sc1
    v_mfma_f32_32x32x16_bf16 v[96:111], a[36:39], v[168:171], v[96:111]
    v_mfma_f32_32x32x16_bf16 v[112:127], a[36:39], v[172:175], v[112:127]
    s_waitcnt vmcnt(14)
    v_mfma_f32_32x32x16_bf16 v[64:79], a[40:43], v[176:179], v[64:79]
    s_add_u32 s8, s8, 4096
    buffer_load_dwordx4 v[168:171], v235, s[56:59], s8 offen offset:0 sc1
    v_mfma_f32_32x32x16_bf16 v[80:95], a[40:43], v[180:183], v[80:95]
    s_add_u32 s9, s9, 4096
    buffer_load_dwordx4 v[172:175], v235, s[56:59], s9 offen offset:0 sc1
    v_mfma_f32_32x32x16_bf16 v[96:111], a[44:47], v[176:179], v[96:111]
    v_mfma_f32_32x32x16_bf16 v[112:127], a[44:47], v[180:183], v[112:127]
    s_waitcnt vmcnt(12)
    s_barrier
    s_cmp_lg_u32 s3, 0
    s_cbranch_scc1 L_w0_35
    s_lshl_b32 s80, s2, 7
    s_add_u32 s80, s80, 65536
    v_mov_b32 v247, s80
    v_mov_b32 v244, s90
    v_mov_b32 v245, s91
    s_mov_b64 s[92:93], exec
    s_mov_b64 exec, 1
    buffer_store_dwordx2 v[244:245], v247, s[56:59], 0 offen sc1
    s_mov_b64 exec, s[92:93]
L_w0_35:
    v_mfma_f32_32x32x16_bf16 v[64:79], a[48:51], v[184:187], v[64:79]
    buffer_load_dwordx4 v[176:179], v235, s[56:59], s8 offen offset:1024 sc1
    v_mfma_f32_32x32x16_bf16 v[80:95], a[48:51], v[188:191], v[80:95]
    buffer_load_dwordx4 v[180:183], v235, s[56:59], s9 offen offset:1024 sc1
    v_mfma_f32_32x32x16_bf16 v[96:111], a[52:55], v[184:187], v[96:111]
    v_mfma_f32_32x32x16_bf16 v[112:127], a[52:55], v[188:191], v[112:127]
    s_waitcnt vmcnt(12)
    v_mfma_f32_32x32x16_bf16 v[64:79], a[56:59], v[192:195], v[64:79]
    buffer_load_dwordx4 v[184:187], v235, s[56:59], s8 offen offset:2048 sc1
    v_mfma_f32_32x32x16_bf16 v[80:95], a[56:59], v[196:199], v[80:95]
    buffer_load_dwordx4 v[188:191], v235, s[56:59], s9 offen offset:2048 sc1
    v_mfma_f32_32x32x16_bf16 v[96:111], a[60:63], v[192:195], v[96:111]
    v_mfma_f32_32x32x16_bf16 v[112:127], a[60:63], v[196:199], v[112:127]
    s_waitcnt vmcnt(12)
    v_mfma_f32_32x32x16_bf16 v[64:79], a[64:67], v[136:139], v[64:79]
    buffer_load_dwordx4 v[192:195], v235, s[56:59], s8 offen offset:3072 sc1
    v_mfma_f32_32x32x16_bf16 v[80:95], a[64:67], v[140:143], v[80:95]
    buffer_load_dwordx4 v[196:199], v235, s[56:59], s9 offen offset:3072 sc1
    v_mfma_f32_32x32x16_bf16 v[96:111], a[68:71], v[136:139], v[96:111]
    v_mfma_f32_32x32x16_bf16 v[112:127], a[68:71], v[140:143], v[112:127]
    s_waitcnt vmcnt(12)
    v_mfma_f32_32x32x16_bf16 v[64:79], a[72:75], v[144:147], v[64:79]
    s_add_u32 s8, s8, 4096
    buffer_load_dwordx4 v[136:139], v235, s[56:59], s8 offen offset:0 sc1
    v_mfma_f32_32x32x16_bf16 v[80:95], a[72:75], v[148:151], v[80:95]
    s_add_u32 s9, s9, 4096
    buffer_load_dwordx4 v[140:143], v235, s[56:59], s9 offen offset:0 sc1
    v_mfma_f32_32x32x16_bf16 v[96:111], a[76:79], v[144:147], v[96:111]
    v_mfma_f32_32x32x16_bf16 v[112:127], a[76:79], v[148:151], v[112:127]
    s_waitcnt vmcnt(12)
    v_mfma_f32_32x32x16_bf16 v[64:79], a[80:83], v[152:155], v[64:79]
    buffer_load_dwordx4 v[144:147], v235, s[56:59], s8 offen offset:1024 sc1
    v_mfma_f32_32x32x16_bf16 v[80:95], a[80:83], v[156:159], v[80:95]
    buffer_load_dwordx4 v[148:151], v235, s[56:59], s9 offen offset:1024 sc1
    v_mfma_f32_32x32x16_bf16 v[96:111], a[84:87], v[152:155], v[96:111]
    v_mfma_f32_32x32x16_bf16 v[112:127], a[84:87], v[156:159], v[112:127]
    s_waitcnt vmcnt(12)
    v_mfma_f32_32x32x16_bf16 v[64:79], a[88:91], v[160:163], v[64:79]
    buffer_load_dwordx4 v[152:155], v235, s[56:59], s8 offen offset:2048 sc1
    v_mfma_f32_32x32x16_bf16 v[80:95], a[88:91], v[164:167], v[80:95]
    buffer_load_dwordx4 v[156:159], v235, s[56:59], s9 offen offset:2048 sc1
    v_mfma_f32_32x32x16_bf16 v[96:111], a[92:95], v[160:163], v[96:111]
    v_mfma_f32_32x32x16_bf16 v[112:127], a[92:95], v[164:167], v[112:127]
    s_waitcnt vmcnt(12)
    v_mfma_f32_32x32x16_bf16 v[64:79], a[96:99], v[168:171], v[64:79]
    buffer_load_dwordx4 v[160:163], v235, s[56:59], s8 offen offset:3072 sc1
    v_mfma_f32_32x32x16_bf16 v[80:95], a[96:99], v[172:175], v[80:95]
    buffer_load_dwordx4 v[164:167], v235, s[56:59], s9 offen offset:3072 sc1
    v_mfma_f32_32x32x16_bf16 v[96:111], a[100:103], v[168:171], v[96:111]
    v_mfma_f32_32x32x16_bf16 v[112:127], a[100:103], v[172:175], v[112:127]
    s_waitcnt vmcnt(12)
    v_mfma_f32_32x32x16_bf16 v[64:79], a[104:107], v[176:179], v[64:79]
    s_add_u32 s8, s8, 4096
    buffer_load_dwordx4 v[168:171], v235, s[56:59], s8 offen offset:0 sc1
    v_mfma_f32_32x32x16_bf16 v[80:95], a[104:107], v[180:183], v[80:95]
    s_add_u32 s9, s9, 4096
    buffer_load_dwordx4 v[172:175], v235, s[56:59], s9 offen offset:0 sc1
    v_mfma_f32_32x32x16_bf16 v[96:111], a[108:111], v[176:179], v[96:111]
    v_mfma_f32_32x32x16_bf16 v[112:127], a[108:111], v[180:183], v[112:127]
    s_cmp_lg_u32 s3, 0
    s_cbranch_scc1 L_w0_36
    v_and_b32 v250, 31, v1
    s_lshl_b32 s82, s73, 5
    v_add_u32 v250, s82, v250
    v_lshlrev_b32 v250, 7, v250
    v_add_u32 v250, 65536, v250
    buffer_load_dwordx2 v[252:253], v250, s[56:59], 0 offen sc1
L_w0_36:
    s_waitcnt vmcnt(12)
    v_mfma_f32_32x32x16_bf16 v[64:79], a[112:115], v[184:187], v[64:79]
    buffer_load_dwordx4 v[176:179], v235, s[56:59], s8 offen offset:1024 sc1
    v_mfma_f32_32x32x16_bf16 v[80:95], a[112:115], v[188:191], v[80:95]
    buffer_load_dwordx4 v[180:183], v235, s[56:59], s9 offen offset:1024 sc1
    v_mfma_f32_32x32x16_bf16 v[96:111], a[116:119], v[184:187], v[96:111]
    v_mfma_f32_32x32x16_bf16 v[112:127], a[116:119], v[188:191], v[112:127]
    s_waitcnt vmcnt(12)
    v_mfma_f32_32x32x16_bf16 v[64:79], a[120:123], v[192:195], v[64:79]
    buffer_load_dwordx4 v[184:187], v235, s[56:59], s8 offen offset:2048 sc1
    v_mfma_f32_32x32x16_bf16 v[80:95], a[120:123], v[196:199], v[80:95]
    buffer_load_dwordx4 v[188:191], v235, s[56:59], s9 offen offset:2048 sc1
    v_mfma_f32_32x32x16_bf16 v[96:111], a[124:127], v[192:195], v[96:111]
    v_mfma_f32_32x32x16_bf16 v[112:127], a[124:127], v[196:199], v[112:127]
    s_waitcnt vmcnt(12)
    v_mfma_f32_32x32x16_bf16 v[64:79], a[128:131], v[136:139], v[64:79]
    buffer_load_dwordx4 v[192:195], v235, s[56:59], s8 offen offset:3072 sc1
    v_mfma_f32_32x32x16_bf16 v[80:95], a[128:131], v[140:143], v[80:95]
    buffer_load_dwordx4 v[196:199], v235, s[56:59], s9 offen offset:3072 sc1
    v_mfma_f32_32x32x16_bf16 v[96:111], a[132:135], v[136:139], v[96:111]
    v_mfma_f32_32x32x16_bf16 v[112:127], a[132:135], v[140:143], v[112:127]
    s_waitcnt vmcnt(12)
    v_mfma_f32_32x32x16_bf16 v[64:79], a[136:139], v[144:147], v[64:79]
    s_add_u32 s8, s8, 4096
    buffer_load_dwordx4 v[136:139], v235, s[56:59], s8 offen offset:0 sc1
    v_mfma_f32_32x32x16_bf16 v[80:95], a[136:139], v[148:151], v[80:95]
    s_add_u32 s9, s9, 4096
    buffer_load_dwordx4 v[140:143], v235, s[56:59], s9 offen offset:0 sc1
    v_mfma_f32_32x32x16_bf16 v[96:111], a[140:143], v[144:147], v[96:111]
    v_mfma_f32_32x32x16_bf16 v[112:127], a[140:143], v[148:151], v[112:127]
    s_cmp_lg_u32 s3, 0
    s_cbranch_scc1 L_w0_37
    s_waitcnt vmcnt(8)
    s_mov_b32 s95, 0
L_poll_38:
    v_cmp_ne_u32 vcc, s90, v252
    v_cmp_ne_u32 s[92:93], s91, v253
    s_nop 1
    s_or_b64 vcc, vcc, s[92:93]
    s_cmp_eq_u64 vcc, 0
    s_cbranch_scc1 L_poll_done_39
    s_add_u32 s95, s95, 1
    s_cmp_ge_u32 s95, 0x40000
    s_cbranch_scc1 L_poll_done_39
    buffer_load_dwordx2 v[252:253], v250, s[56:59], 0 offen sc1
    s_waitcnt vmcnt(0)
    s_branch L_poll_38
L_poll_done_39:
L_w0_37:
    s_barrier
    s_waitcnt vmcnt(12)
    v_mfma_f32_32x32x16_bf16 v[64:79], a[144:147], v[152:155], v[64:79]
    buffer_load_dwordx4 v[144:147], v235, s[56:59], s8 offen offset:1024 sc1
    v_mfma_f32_32x32x16_bf16 v[80:95], a[144:147], v[156:159], v[80:95]
    buffer_load_dwordx4 v[148:151], v235, s[56:59], s9 offen offset:1024 sc1
    v_mfma_f32_32x32x16_bf16 v[96:111], a[148:151], v[152:155], v[96:111]
    v_lshrrev_b32 v12, 3, v1
    v_and_b32 v13, 7, v1
    v_lshlrev_b32 v14, 12, v12
    v_lshl_or_b32 v14, v13, 4, v14
    s_lshl_b32 s80, s73, 18
    s_lshl_b32 s81, s3, 16
    s_add_u32 s80, s80, s81
    s_lshl_b32 s81, s72, 7
    s_add_u32 s80, s80, s81
    s_add_u32 s80, s80, 3145728
    buffer_load_dwordx4 v[212:215], v14, s[56:59], s80 offen sc1
    s_add_u32 s80, s80, 32768
    buffer_load_dwordx4 v[216:219], v14, s[56:59], s80 offen sc1
    v_mfma_f32_32x32x16_bf16 v[112:127], a[148:151], v[156:159], v[112:127]
    v_and_b32 v24, 31, v1
    v_lshrrev_b32 v25, 5, v1
    s_lshl_b32 s80, s72, 9
    s_lshl_b32 s81, s87, 8
    s_add_u32 s80, s80, s81
    s_add_u32 s80, s80, 131072
    v_lshlrev_b32 v26, 3, v24
    buffer_load_dwordx2 v[28:29], v26, s[56:59], s80 offen sc1
    s_lshl_b32 s80, s73, 7
    s_lshl_b32 s81, s86, 6
    s_add_u32 s80, s80, s81
    v_lshl_add_u32 v26, v25, 3, s80
    global_load_dwordx2 v[32:33], v26, s[14:15] offset:0
    global_load_dwordx2 v[34:35], v26, s[14:15] offset:16
    global_load_dwordx2 v[36:37], v26, s[14:15] offset:32
    global_load_dwordx2 v[38:39], v26, s[14:15] offset:48
    s_waitcnt vmcnt(19)
    v_mfma_f32_32x32x16_bf16 v[64:79], a[152:155], v[160:163], v[64:79]
    buffer_load_dwordx4 v[152:155], v235, s[56:59], s8 offen offset:2048 sc1
    v_mfma_f32_32x32x16_bf16 v[80:95], a[152:155], v[164:167], v[80:95]
    buffer_load_dwordx4 v[156:159], v235, s[56:59], s9 offen offset:2048 sc1
    v_mfma_f32_32x32x16_bf16 v[96:111], a[156:159], v[160:163], v[96:111]
    v_bfe_u32 v14, v1, 4, 1
    v_lshlrev_b32 v14, 2, v14
    v_xor_b32 v14, v14, v13
    v_lshlrev_b32 v14, 4, v14
    v_lshl_or_b32 v14, v12, 7, v14
    s_lshl_b32 s80, s3, 11
    s_add_u32 s80, s80, 114688
    v_add_u32 v14, s80, v14
    v_mfma_f32_32x32x16_bf16 v[112:127], a[156:159], v[164:167], v[112:127]
    v_bfe_u32 v15, v1, 1, 3
    s_lshl_b32 s80, s86, 2
    v_xor_b32 v15, s80, v15
    v_lshlrev_b32 v15, 4, v15
    v_lshl_or_b32 v15, v25, 3, v15
    v_lshl_or_b32 v15, v24, 7, v15
    s_lshl_b32 s80, s87, 12
    v_add_u32 v15, s80, v15
    s_waitcnt vmcnt(19)
    v_mfma_f32_32x32x16_bf16 v[64:79], a[160:163], v[168:171], v[64:79]
    buffer_load_dwordx4 v[160:163], v235, s[56:59], s8 offen offset:3072 sc1
    v_mfma_f32_32x32x16_bf16 v[80:95], a[160:163], v[172:175], v[80:95]
    buffer_load_dwordx4 v[164:167], v235, s[56:59], s9 offen offset:3072 sc1
    v_mfma_f32_32x32x16_bf16 v[96:111], a[164:167], v[168:171], v[96:111]
    v_xor_b32 v40, 0, v15
    v_add_u32 v44, 122880, v40
    v_add_u32 v40, 131072, v40
    v_xor_b32 v41, 16, v15
    v_add_u32 v45, 122880, v41
    v_add_u32 v41, 131072, v41
    v_xor_b32 v42, 32, v15
    v_add_u32 v46, 122880, v42
    v_add_u32 v42, 131072, v42
    v_xor_b32 v43, 48, v15
    v_add_u32 v47, 122880, v43
    v_add_u32 v43, 131072, v43
    v_mfma_f32_32x32x16_bf16 v[112:127], a[164:167], v[172:175], v[112:127]
    v_bfe_u32 v16, v1, 2, 2
    v_lshl_add_u32 v16, v25, 2, v16
    s_lshl_b32 s80, s86, 5
    v_add_u32 v16, s80, v16
    v_lshlrev_b32 v16, 7, v16
    v_bfe_u32 v17, v1, 3, 1
    v_xor_b32 v17, s87, v17
    v_lshl_or_b32 v16, v17, 6, v16
    v_bfe_u32 v17, v1, 4, 1
    v_lshl_or_b32 v16, v17, 5, v16
    v_and_b32 v17, 3, v1
    v_lshl_or_b32 v16, v17, 3, v16
    v_add_u32 v16, 114688, v16
    s_waitcnt vmcnt(19)
    v_mfma_f32_32x32x16_bf16 v[64:79], a[168:171], v[176:179], v[64:79]
    v_mfma_f32_32x32x16_bf16 v[80:95], a[168:171], v[180:183], v[80:95]
    v_mfma_f32_32x32x16_bf16 v[96:111], a[172:175], v[176:179], v[96:111]
    v_mfma_f32_32x32x16_bf16 v[112:127], a[172:175], v[180:183], v[112:127]
    s_waitcnt vmcnt(17)
    v_mfma_f32_32x32x16_bf16 v[64:79], a[176:179], v[184:187], v[64:79]
    v_mfma_f32_32x32x16_bf16 v[80:95], a[176:179], v[188:191], v[80:95]
    v_mfma_f32_32x32x16_bf16 v[96:111], a[180:183], v[184:187], v[96:111]
    v_mfma_f32_32x32x16_bf16 v[112:127], a[180:183], v[188:191], v[112:127]
    s_waitcnt vmcnt(15)
    v_mfma_f32_32x32x16_bf16 v[64:79], a[184:187], v[192:195], v[64:79]
    v_mfma_f32_32x32x16_bf16 v[80:95], a[184:187], v[196:199], v[80:95]
    v_mfma_f32_32x32x16_bf16 v[96:111], a[188:191], v[192:195], v[96:111]
    v_mfma_f32_32x32x16_bf16 v[112:127], a[188:191], v[196:199], v[112:127]
    s_waitcnt vmcnt(13)
    v_mfma_f32_32x32x16_bf16 v[64:79], a[192:195], v[136:139], v[64:79]
    v_mfma_f32_32x32x16_bf16 v[80:95], a[192:195], v[140:143], v[80:95]
    v_mfma_f32_32x32x16_bf16 v[96:111], a[196:199], v[136:139], v[96:111]
    v_mfma_f32_32x32x16_bf16 v[112:127], a[196:199], v[140:143], v[112:127]
    s_waitcnt vmcnt(11)
    v_mfma_f32_32x32x16_bf16 v[64:79], a[200:203], v[144:147], v[64:79]
    v_mfma_f32_32x32x16_bf16 v[80:95], a[200:203], v[148:151], v[80:95]
    v_mfma_f32_32x32x16_bf16 v[96:111], a[204:207], v[144:147], v[96:111]
    s_waitcnt vmcnt(10)
    ds_write_b128 v14, v[212:215]
    s_waitcnt vmcnt(9)
    ds_write_b128 v14, v[216:219] offset:1024
    v_mfma_f32_32x32x16_bf16 v[112:127], a[204:207], v[148:151], v[112:127]
    s_waitcnt vmcnt(2)
    v_mfma_f32_32x32x16_bf16 v[64:79], a[208:211], v[152:155], v[64:79]
    v_mfma_f32_32x32x16_bf16 v[80:95], a[208:211], v[156:159], v[80:95]
    v_mfma_f32_32x32x16_bf16 v[96:111], a[212:215], v[152:155], v[96:111]
    v_mfma_f32_32x32x16_bf16 v[112:127], a[212:215], v[156:159], v[112:127]
    s_waitcnt vmcnt(0)
    v_mfma_f32_32x32x16_bf16 v[64:79], a[216:219], v[160:163], v[64:79]
    v_mfma_f32_32x32x16_bf16 v[80:95], a[216:219], v[164:167], v[80:95]
    v_mfma_f32_32x32x16_bf16 v[96:111], a[220:223], v[160:163], v[96:111]
    v_mfma_f32_32x32x16_bf16 v[112:127], a[220:223], v[164:167], v[112:127]
    s_xor_b32 s80, s3, 1
    s_mul_i32 s80, s80, 3
    s_add_u32 s80, s80, 0
    s_lshl_b32 s80, s80, 12
    s_add_u32 s80, s80, 65536
    v_lshl_add_u32 v9, v1, 4, s80
    s_xor_b32 s80, s3, 2
    s_mul_i32 s80, s80, 3
    s_add_u32 s80, s80, 1
    s_lshl_b32 s80, s80, 12
    s_add_u32 s80, s80, 65536
    v_lshl_add_u32 v10, v1, 4, s80
    s_xor_b32 s80, s3, 3
    s_mul_i32 s80, s80, 3
    s_add_u32 s80, s80, 2
    s_lshl_b32 s80, s80, 12
    s_add_u32 s80, s80, 65536
    v_lshl_add_u32 v11, v1, 4, s80
    ds_write_b128 v9, v[80:83] offset:0
    ds_write_b128 v9, v[84:87] offset:1024
    ds_write_b128 v9, v[88:91] offset:2048
    ds_write_b128 v9, v[92:95] offset:3072
    ds_write_b128 v10, v[96:99] offset:0
    ds_write_b128 v10, v[100:103] offset:1024
    ds_write_b128 v10, v[104:107] offset:2048
    ds_write_b128 v10, v[108:111] offset:3072
    ds_write_b128 v11, v[112:115] offset:0
    ds_write_b128 v11, v[116:119] offset:1024
    ds_write_b128 v11, v[120:123] offset:2048
    ds_write_b128 v11, v[124:127] offset:3072
    s_mul_i32 s80, s3, 12288
    s_add_u32 s80, s80, 65536
    v_lshl_add_u32 v8, v1, 4, s80
    s_waitcnt lgkmcnt(0)
    s_barrier
    ds_read_b128 v[80:83], v8 offset:0
    ds_read_b128 v[84:87], v8 offset:1024
    ds_read_b128 v[88:91], v8 offset:2048
    ds_read_b128 v[92:95], v8 offset:3072
    ds_read_b64_tr_b16 v[128:129], v16 offset:0
    ds_read_b64_tr_b16 v[130:131], v16 offset:1024
    ds_read_b64_tr_b16 v[132:133], v16 offset:2048
    ds_read_b64_tr_b16 v[134:135], v16 offset:3072
    ds_read_b128 v[96:99], v8 offset:4096
    ds_read_b128 v[100:103], v8 offset:5120
    ds_read_b128 v[104:107], v8 offset:6144
    ds_read_b128 v[108:111], v8 offset:7168
    ds_read_b128 v[112:115], v8 offset:8192
    ds_read_b128 v[116:119], v8 offset:9216
    ds_read_b128 v[120:123], v8 offset:10240
    ds_read_b128 v[124:127], v8 offset:11264
    ds_read_b64 v[48:49], v40
    ds_read_b64 v[56:57], v40 offset:8192
    ds_read_b64 v[50:51], v41
    ds_read_b64 v[58:59], v41 offset:8192
    ds_read_b64 v[52:53], v42
    ds_read_b64 v[60:61], v42 offset:8192
    ds_read_b64 v[54:55], v43
    ds_read_b64 v[62:63], v43 offset:8192
    v_mul_f32 v30, v28, v29
    v_sub_f32 v30, 0, v30
    v_mov_b32 v31, v30
    v_mov_b32 v28, v29
    s_mov_b32 s80, 0x3f317218
    s_mov_b32 s81, 0x3f317218
    s_waitcnt lgkmcnt(15)
    v_pk_add_f32 v[64:65], v[64:65], v[80:81]
    v_pk_add_f32 v[66:67], v[66:67], v[82:83]
    s_waitcnt lgkmcnt(15)
    v_pk_add_f32 v[68:69], v[68:69], v[84:85]
    v_pk_add_f32 v[70:71], v[70:71], v[86:87]
    s_waitcnt lgkmcnt(15)
    v_pk_add_f32 v[72:73], v[72:73], v[88:89]
    v_pk_add_f32 v[74:75], v[74:75], v[90:91]
    s_waitcnt lgkmcnt(15)
    v_pk_add_f32 v[76:77], v[76:77], v[92:93]
    v_pk_add_f32 v[78:79], v[78:79], v[94:95]
    s_waitcnt lgkmcnt(15)
    v_pk_add_f32 v[64:65], v[64:65], v[96:97]
    v_pk_add_f32 v[66:67], v[66:67], v[98:99]
    s_waitcnt lgkmcnt(14)
    v_pk_add_f32 v[68:69], v[68:69], v[100:101]
    v_pk_add_f32 v[70:71], v[70:71], v[102:103]
    s_waitcnt lgkmcnt(13)
    v_pk_add_f32 v[72:73], v[72:73], v[104:105]
    v_pk_add_f32 v[74:75], v[74:75], v[106:107]
    s_waitcnt lgkmcnt(12)
    v_pk_add_f32 v[76:77], v[76:77], v[108:109]
    v_pk_add_f32 v[78:79], v[78:79], v[110:111]
    s_waitcnt lgkmcnt(11)
    v_pk_add_f32 v[64:65], v[64:65], v[112:113]
    v_pk_add_f32 v[66:67], v[66:67], v[114:115]
    s_waitcnt lgkmcnt(10)
    v_pk_add_f32 v[68:69], v[68:69], v[116:117]
    v_pk_add_f32 v[70:71], v[70:71], v[118:119]
    s_waitcnt lgkmcnt(9)
    v_pk_add_f32 v[72:73], v[72:73], v[120:121]
    v_pk_add_f32 v[74:75], v[74:75], v[122:123]
    s_waitcnt lgkmcnt(8)
    v_pk_add_f32 v[76:77], v[76:77], v[124:125]
    v_pk_add_f32 v[78:79], v[78:79], v[126:127]
    v_exp_f32 v168, -v64
    v_exp_f32 v169, -v65
    v_exp_f32 v170, -v66
    v_exp_f32 v171, -v67
    s_waitcnt lgkmcnt(6)
    v_lshlrev_b32 v152, 16, v56
    v_and_b32 v153, 0xffff0000, v56
    v_lshlrev_b32 v154, 16, v57
    v_and_b32 v155, 0xffff0000, v57
    v_lshlrev_b32 v156, 16, v128
    v_and_b32 v157, 0xffff0000, v128
    v_lshlrev_b32 v158, 16, v129
    v_and_b32 v159, 0xffff0000, v129
    v_lshlrev_b32 v160, 16, v48
    v_and_b32 v161, 0xffff0000, v48
    v_lshlrev_b32 v162, 16, v49
    v_and_b32 v163, 0xffff0000, v49
    v_lshlrev_b32 v164, 16, v32
    v_and_b32 v165, 0xffff0000, v32
    v_lshlrev_b32 v166, 16, v33
    v_and_b32 v167, 0xffff0000, v33
    v_pk_add_f32 v[168:169], v[168:169], 1.0 op_sel_hi:[1,0]
    v_pk_add_f32 v[170:171], v[170:171], 1.0 op_sel_hi:[1,0]
    v_rcp_f32 v168, v168
    v_rcp_f32 v169, v169
    v_rcp_f32 v170, v170
    v_rcp_f32 v171, v171
    v_pk_fma_f32 v[156:157], v[160:161], v[164:165], v[156:157]
    v_pk_fma_f32 v[160:161], v[152:153], v[28:29], v[30:31]
    v_pk_mul_f32 v[64:65], v[64:65], s[80:81]
    v_pk_fma_f32 v[158:159], v[162:163], v[166:167], v[158:159]
    v_pk_fma_f32 v[162:163], v[154:155], v[28:29], v[30:31]
    v_pk_mul_f32 v[66:67], v[66:67], s[80:81]
    v_pk_mul_f32 v[156:157], v[156:157], v[160:161]
    v_pk_mul_f32 v[64:65], v[64:65], v[168:169]
    v_pk_mul_f32 v[158:159], v[158:159], v[162:163]
    v_pk_mul_f32 v[66:67], v[66:67], v[170:171]
    v_pk_fma_f32 v[152:153], v[156:157], v[64:65], v[152:153]
    v_pk_fma_f32 v[154:155], v[158:159], v[66:67], v[154:155]
    v_cvt_pk_bf16_f32 v172, v152, v153
    v_cvt_pk_bf16_f32 v173, v154, v155
    ds_write_b64 v44, v[172:173]
    v_exp_f32 v168, -v68
    v_exp_f32 v169, -v69
    v_exp_f32 v170, -v70
    v_exp_f32 v171, -v71
    s_waitcnt lgkmcnt(5)
    v_lshlrev_b32 v152, 16, v58
    v_and_b32 v153, 0xffff0000, v58
    v_lshlrev_b32 v154, 16, v59
    v_and_b32 v155, 0xffff0000, v59
    v_lshlrev_b32 v156, 16, v130
    v_and_b32 v157, 0xffff0000, v130
    v_lshlrev_b32 v158, 16, v131
    v_and_b32 v159, 0xffff0000, v131
    v_lshlrev_b32 v160, 16, v50
    v_and_b32 v161, 0xffff0000, v50
    v_lshlrev_b32 v162, 16, v51
    v_and_b32 v163, 0xffff0000, v51
    v_lshlrev_b32 v164, 16, v34
    v_and_b32 v165, 0xffff0000, v34
    v_lshlrev_b32 v166, 16, v35
    v_and_b32 v167, 0xffff0000, v35
    v_pk_add_f32 v[168:169], v[168:169], 1.0 op_sel_hi:[1,0]
    v_pk_add_f32 v[170:171], v[170:171], 1.0 op_sel_hi:[1,0]
    v_rcp_f32 v168, v168
    v_rcp_f32 v169, v169
    v_rcp_f32 v170, v170
    v_rcp_f32 v171, v171
    v_pk_fma_f32 v[156:157], v[160:161], v[164:165], v[156:157]
    v_pk_fma_f32 v[160:161], v[152:153], v[28:29], v[30:31]
    v_pk_mul_f32 v[68:69], v[68:69], s[80:81]
    v_pk_fma_f32 v[158:159], v[162:163], v[166:167], v[158:159]
    v_pk_fma_f32 v[162:163], v[154:155], v[28:29], v[30:31]
    v_pk_mul_f32 v[70:71], v[70:71], s[80:81]
    v_pk_mul_f32 v[156:157], v[156:157], v[160:161]
    v_pk_mul_f32 v[68:69], v[68:69], v[168:169]
    v_pk_mul_f32 v[158:159], v[158:159], v[162:163]
    v_pk_mul_f32 v[70:71], v[70:71], v[170:171]
    v_pk_fma_f32 v[152:153], v[156:157], v[68:69], v[152:153]
    v_pk_fma_f32 v[154:155], v[158:159], v[70:71], v[154:155]
    v_cvt_pk_bf16_f32 v174, v152, v153
    v_cvt_pk_bf16_f32 v175, v154, v155
    ds_write_b64 v45, v[174:175]
    v_exp_f32 v168, -v72
    v_exp_f32 v169, -v73
    v_exp_f32 v170, -v74
    v_exp_f32 v171, -v75
    s_waitcnt lgkmcnt(4)
    v_lshlrev_b32 v152, 16, v60
    v_and_b32 v153, 0xffff0000, v60
    v_lshlrev_b32 v154, 16, v61
    v_and_b32 v155, 0xffff0000, v61
    v_lshlrev_b32 v156, 16, v132
    v_and_b32 v157, 0xffff0000, v132
    v_lshlrev_b32 v158, 16, v133
    v_and_b32 v159, 0xffff0000, v133
    v_lshlrev_b32 v160, 16, v52
    v_and_b32 v161, 0xffff0000, v52
    v_lshlrev_b32 v162, 16, v53
    v_and_b32 v163, 0xffff0000, v53
    v_lshlrev_b32 v164, 16, v36
    v_and_b32 v165, 0xffff0000, v36
    v_lshlrev_b32 v166, 16, v37
    v_and_b32 v167, 0xffff0000, v37
    v_pk_add_f32 v[168:169], v[168:169], 1.0 op_sel_hi:[1,0]
    v_pk_add_f32 v[170:171], v[170:171], 1.0 op_sel_hi:[1,0]
    v_rcp_f32 v168, v168
    v_rcp_f32 v169, v169
    v_rcp_f32 v170, v170
    v_rcp_f32 v171, v171
    v_pk_fma_f32 v[156:157], v[160:161], v[164:165], v[156:157]
    v_pk_fma_f32 v[160:161], v[152:153], v[28:29], v[30:31]
    v_pk_mul_f32 v[72:73], v[72:73], s[80:81]
    v_pk_fma_f32 v[158:159], v[162:163], v[166:167], v[158:159]
    v_pk_fma_f32 v[162:163], v[154:155], v[28:29], v[30:31]
    v_pk_mul_f32 v[74:75], v[74:75], s[80:81]
    v_pk_mul_f32 v[156:157], v[156:157], v[160:161]
    v_pk_mul_f32 v[72:73], v[72:73], v[168:169]
    v_pk_mul_f32 v[158:159], v[158:159], v[162:163]
    v_pk_mul_f32 v[74:75], v[74:75], v[170:171]
    v_pk_fma_f32 v[152:153], v[156:157], v[72:73], v[152:153]
    v_pk_fma_f32 v[154:155], v[158:159], v[74:75], v[154:155]
    v_cvt_pk_bf16_f32 v172, v152, v153
    v_cvt_pk_bf16_f32 v173, v154, v155
    ds_write_b64 v46, v[172:173]
    v_exp_f32 v168, -v76
    v_exp_f32 v169, -v77
    v_exp_f32 v170, -v78
    v_exp_f32 v171, -v79
    s_waitcnt lgkmcnt(3)
    v_lshlrev_b32 v152, 16, v62
    v_and_b32 v153, 0xffff0000, v62
    v_lshlrev_b32 v154, 16, v63
    v_and_b32 v155, 0xffff0000, v63
    v_lshlrev_b32 v156, 16, v134
    v_and_b32 v157, 0xffff0000, v134
    v_lshlrev_b32 v158, 16, v135
    v_and_b32 v159, 0xffff0000, v135
    v_lshlrev_b32 v160, 16, v54
    v_and_b32 v161, 0xffff0000, v54
    v_lshlrev_b32 v162, 16, v55
    v_and_b32 v163, 0xffff0000, v55
    v_lshlrev_b32 v164, 16, v38
    v_and_b32 v165, 0xffff0000, v38
    v_lshlrev_b32 v166, 16, v39
    v_and_b32 v167, 0xffff0000, v39
    v_pk_add_f32 v[168:169], v[168:169], 1.0 op_sel_hi:[1,0]
    v_pk_add_f32 v[170:171], v[170:171], 1.0 op_sel_hi:[1,0]
    v_rcp_f32 v168, v168
    v_rcp_f32 v169, v169
    v_rcp_f32 v170, v170
    v_rcp_f32 v171, v171
    v_pk_fma_f32 v[156:157], v[160:161], v[164:165], v[156:157]
    v_pk_fma_f32 v[160:161], v[152:153], v[28:29], v[30:31]
    v_pk_mul_f32 v[76:77], v[76:77], s[80:81]
    v_pk_fma_f32 v[158:159], v[162:163], v[166:167], v[158:159]
    v_pk_fma_f32 v[162:163], v[154:155], v[28:29], v[30:31]
    v_pk_mul_f32 v[78:79], v[78:79], s[80:81]
    v_pk_mul_f32 v[156:157], v[156:157], v[160:161]
    v_pk_mul_f32 v[76:77], v[76:77], v[168:169]
    v_pk_mul_f32 v[158:159], v[158:159], v[162:163]
    v_pk_mul_f32 v[78:79], v[78:79], v[170:171]
    v_pk_fma_f32 v[152:153], v[156:157], v[76:77], v[152:153]
    v_pk_fma_f32 v[154:155], v[158:159], v[78:79], v[154:155]
    v_cvt_pk_bf16_f32 v174, v152, v153
    v_cvt_pk_bf16_f32 v175, v154, v155
    ds_write_b64 v47, v[174:175]
    v_lshrrev_b32 v9, 4, v1
    v_xor_b32 v10, v13, v9
    v_lshlrev_b32 v12, 10, v12
    v_lshl_or_b32 v10, v10, 4, v12
    v_xor_b32 v11, 64, v10
    s_lshl_b32 s80, s3, 11
    s_add_u32 s80, s80, 122880
    v_lshl_add_u32 v9, v1, 4, s80
    s_waitcnt lgkmcnt(0)
    s_barrier
    ds_read_b128 v[16:19], v9
    ds_read_b128 v[20:23], v9 offset:1024
    s_lshl_b32 s80, s72, 16
    s_lshl_b32 s81, s73, 7
    s_add_u32 s80, s80, s81
    s_lshl_b32 s81, s3, 14
    s_add_u32 s80, s80, s81
    s_waitcnt lgkmcnt(1)
    buffer_store_dwordx4 v[16:19], v10, s[60:63], s80 offen
    s_add_u32 s80, s80, 8192
    s_waitcnt lgkmcnt(0)
    buffer_store_dwordx4 v[20:23], v11, s[60:63], s80 offen
    s_waitcnt vmcnt(0) lgkmcnt(0)
    s_endpgm
L_codeend:
.section .rodata,"a"
.p2align 6
.amdhsa_kernel recurrent_scan__ssm_conv_h3__dense_activation_mish__prompt_kernel
  .amdhsa_next_free_vgpr 512
  .amdhsa_next_free_sgpr 102
  .amdhsa_accum_offset 256
  .amdhsa_group_segment_fixed_size 0
  .amdhsa_kernarg_size 104
  .amdhsa_user_sgpr_count 2
  .amdhsa_user_sgpr_kernarg_segment_ptr 1
  .amdhsa_system_sgpr_workgroup_id_x 1
.end_amdhsa_kernel
```
